```python
import torch

def _softmax(x, axis=-1):
    return torch.softmax(x, dim=axis)

def _gelu(x):
    return torch.nn.functional.gelu(x, approximate='tanh')

def _silu(x):
    return torch.nn.functional.silu(x)

def _sigmoid(x):
    return torch.sigmoid(x)

def _layernorm(x, axis=-1, eps=1e-05):
    m = x.mean(dim=axis, keepdim=True)
    v = x.var(dim=axis, keepdim=True, unbiased=False)
    return (x - m) / torch.sqrt(v + eps)

def _scatter_add(tgt, idx, src, axis=0):
    return tgt.clone().index_add_(axis, idx, src)

def _segment_sum(src, seg, n):
    out = torch.zeros((n,) + src.shape[1:], dtype=src.dtype)
    return out.index_add_(0, seg, src)

def _pad(x, pw):
    flat = tuple((v for pair in reversed(pw) for v in pair))
    return torch.nn.functional.pad(x, flat)
kernel_name = 'adaLN_cond__gqa_block_cached__glu_gated_geglu__decode'

def setup_inputs():

    _w = lambda a: (lambda t: t.to(torch.bfloat16) if t.is_floating_point() else t)(torch.as_tensor(a))

    def _A_setup():
        B, Sq, D = (4, 1, 512)
        Hq, Hkv, Sk, Dh = (32, 8, 8192, 128)
        assert Hq % Hkv == 0, (Hq, Hkv)
        return {'x': _w((lambda *s: torch.randn(*s, dtype=torch.bfloat16) * 0.05)(B, Sq, D)), 'k_cache': _w((lambda *s: torch.randn(*s, dtype=torch.bfloat16) * 0.8)(B, Hkv, Sk, Dh)), 'v_cache': _w((lambda *s: torch.randn(*s, dtype=torch.bfloat16) * 3.2)(B, Hkv, Sk, Dh)), 'wq': _w((lambda *s: torch.randn(*s, dtype=torch.bfloat16) * 0.8)(D, Hq * Dh) * D ** (-0.5)), 'wo': _w((lambda *s: torch.randn(*s, dtype=torch.bfloat16) * 3.2)(Hq * Dh, D) * (Hq * Dh) ** (-0.5))}
    _A_in = _A_setup()

    def _B_setup():
        B, S, Dm, Df = (4, 1, 512, 1792)
        return {'x': _w((lambda *s: torch.randn(*s, dtype=torch.bfloat16) * 0.05)(B, S, Dm)), 'w_gate': _w((lambda *s: torch.randn(*s, dtype=torch.bfloat16) * 3.2)(Dm, Df) * Dm ** (-0.5)), 'w_up': _w((lambda *s: torch.randn(*s, dtype=torch.bfloat16) * 3.2)(Dm, Df) * Dm ** (-0.5)), 'w_down': _w((lambda *s: torch.randn(*s, dtype=torch.bfloat16) * 3.2)(Df, Dm) * Df ** (-0.5))}
    _B_in = _B_setup()
    return {'A_x': _A_in['x'], 'A_k_cache': _A_in['k_cache'], 'A_v_cache': _A_in['v_cache'], 'A_wq': _A_in['wq'], 'A_wo': _A_in['wo'], 'B_x': _B_in['x'], 'B_w_gate': _B_in['w_gate'], 'B_w_up': _B_in['w_up'], 'B_w_down': _B_in['w_down'], 'c': _w((lambda *s: torch.randn(*s, dtype=torch.bfloat16) * 0.1)(4, 512) * 8.0), 'w_mod': _w((lambda *s: torch.randn(*s, dtype=torch.bfloat16) * 0.1)(512, 6 * 512) * 512 ** (-0.5) * 8.0)}

def reference(A_x, A_k_cache, A_v_cache, A_wq, A_wo, B_x, B_w_gate, B_w_up, B_w_down, c, w_mod):

    def _A_ref(x, k_cache, v_cache, wq, wo):
        B, Sq, D = x.shape
        Hq, Dh = (32, 128)
        Hkv = k_cache.shape[1]
        rep = Hq // Hkv
        q = (lambda x, *d: x.permute(*d))((x @ wq).reshape(B, Sq, Hq, Dh), 0, 2, 1, 3)
        k = (lambda x, n, axis: torch.repeat_interleave(x, n, dim=axis))(k_cache, rep, axis=1)
        v = (lambda x, n, axis: torch.repeat_interleave(x, n, dim=axis))(v_cache, rep, axis=1)
        scores = torch.einsum('bhqd,bhkd->bhqk', q, k) * Dh ** (-0.5)
        p = _softmax(scores, axis=-1)
        o = torch.einsum('bhqk,bhkd->bhqd', p, v)
        return (lambda x, *d: x.permute(*d))(o, 0, 2, 1, 3).reshape(B, Sq, Hq * Dh) @ wo

    def _B_ref(x, w_gate, w_up, w_down):
        g = torch.einsum('bsd,df->bsf', x, w_gate)
        u = torch.einsum('bsd,df->bsf', x, w_up)
        h = _gelu(g) * u
        return torch.einsum('bsf,fd->bsd', h, w_down)
    x = A_x
    mod = (_silu(c) @ w_mod).reshape(c.shape[0], 6, 1, -1)
    sa, ca, ga, sb, cb, gb = (mod[:, 0].clone(), mod[:, 1].clone(), mod[:, 2].clone(), mod[:, 3].clone(), mod[:, 4].clone(), mod[:, 5].clone())
    h = _layernorm(x, axis=-1) * (1 + ca) + sa
    x = x + ga * _A_ref(h, A_k_cache, A_v_cache, A_wq, A_wo)
    h = _layernorm(x, axis=-1) * (1 + cb) + sb
    x = x + gb * _B_ref(h, B_w_gate, B_w_up, B_w_down)
    return x
```

```asm
; @launch grid=(256,1,1) block=(512,1,1) lds=157952
.amdgcn_target "amdgcn-amd-amdhsa--gfx950"
.text
.globl adaLN_cond__gqa_block_cached__glu_gated_geglu__decode_kernel
.p2align 8
.type adaLN_cond__gqa_block_cached__glu_gated_geglu__decode_kernel,@function
adaLN_cond__gqa_block_cached__glu_gated_geglu__decode_kernel:
  s_cmp_ge_u32 s2, 256
  s_cbranch_scc1 L_end
  s_load_dwordx16 s[4:19], s[0:1], 0
  s_load_dwordx8 s[20:27], s[0:1], 64
  s_load_dwordx4 s[28:31], s[0:1], 96
  v_lshrrev_b32 v1, 6, v0
  s_and_b32 s32, s2, 7
  s_lshr_b32 s33, s2, 3
  v_readfirstlane_b32 s3, v1
  v_and_b32 v0, 63, v0
  s_and_b32 s34, s33, 3
  s_lshr_b32 s35, s33, 2
  s_lshl_b32 s54, s34, 3
  s_add_u32 s54, s54, s32
  s_cmp_lt_u32 s3, 4
  s_cbranch_scc1 L_stream
  s_branch L_helper
L_stream:
  v_lshlrev_b32 v1, 4, v0
  v_lshrrev_b32 v13, 4, v0
  v_and_b32 v14, 15, v0
  v_lshl_add_u32 v2, v13, 2, 0
  v_xor_b32 v2, v2, v14
  v_lshlrev_b32 v2, 4, v2
  v_lshl_add_u32 v2, v13, 8, v2
  v_lshl_add_u32 v3, v13, 2, 1
  v_xor_b32 v3, v3, v14
  v_lshlrev_b32 v3, 4, v3
  v_lshl_add_u32 v3, v13, 8, v3
  v_lshl_add_u32 v4, v13, 2, 2
  v_xor_b32 v4, v4, v14
  v_lshlrev_b32 v4, 4, v4
  v_lshl_add_u32 v4, v13, 8, v4
  v_lshl_add_u32 v5, v13, 2, 3
  v_xor_b32 v5, v5, v14
  v_lshlrev_b32 v5, 4, v5
  v_lshl_add_u32 v5, v13, 8, v5
  s_lshl_b32 s46, s3, 15
  s_lshl_b32 s59, s35, 2
  s_add_u32 s59, s59, s3
  s_mul_i32 s59, s59, 2048
  s_mov_b32 s61, s59
  s_mul_i32 s60, s54, 65536
  s_and_b32 s60, s60, 0x1fffff
  s_mov_b32 s62, s60
  s_add_u32 s44, s59, s60
  s_mov_b32 s45, s44
  s_lshl_b32 s54, s54, 21
  s_mov_b32 s38, 0x200000
  s_mov_b32 s39, 0x20000
  s_mov_b32 s42, 0x200000
  s_mov_b32 s43, 0x20000
  s_waitcnt lgkmcnt(0)
  s_add_u32 s36, s6, s54
  s_addc_u32 s37, s7, 0
  s_and_b32 s37, s37, 0xffff
  s_add_u32 s40, s8, s54
  s_addc_u32 s41, s9, 0
  s_and_b32 s41, s41, 0xffff
  s_add_u32 m0, s46, 0
  s_nop 0
  buffer_load_dwordx4 v2, s[36:39], s44 offen offset:0 nt lds
  buffer_load_dwordx4 v3, s[36:39], s44 offen offset:1024 nt lds
  s_add_u32 s59, s59, 10240
  s_and_b32 s59, s59, 65535
  s_add_u32 s60, s60, 65536
  s_and_b32 s60, s60, 0x1fffff
  s_add_u32 s44, s59, s60
  s_add_u32 m0, s46, 2048
  s_nop 0
  buffer_load_dwordx4 v4, s[36:39], s44 offen offset:0 nt lds
  buffer_load_dwordx4 v5, s[36:39], s44 offen offset:1024 nt lds
  s_add_u32 s59, s59, 10240
  s_and_b32 s59, s59, 65535
  s_add_u32 s60, s60, 65536
  s_and_b32 s60, s60, 0x1fffff
  s_add_u32 s44, s59, s60
  s_add_u32 m0, s46, 4096
  s_nop 0
  buffer_load_dwordx4 v2, s[36:39], s44 offen offset:0 nt lds
  buffer_load_dwordx4 v3, s[36:39], s44 offen offset:1024 nt lds
  s_add_u32 s59, s59, 10240
  s_and_b32 s59, s59, 65535
  s_add_u32 s60, s60, 65536
  s_and_b32 s60, s60, 0x1fffff
  s_add_u32 s44, s59, s60
  s_add_u32 m0, s46, 6144
  s_waitcnt vmcnt(5)
  buffer_load_dwordx4 v4, s[36:39], s44 offen offset:0 nt lds
  s_waitcnt vmcnt(5)
  buffer_load_dwordx4 v5, s[36:39], s44 offen offset:1024 nt lds
  s_add_u32 s59, s59, 10240
  s_and_b32 s59, s59, 65535
  s_add_u32 s60, s60, 65536
  s_and_b32 s60, s60, 0x1fffff
  s_add_u32 s44, s59, s60
  s_barrier
  s_waitcnt vmcnt(5)
  buffer_load_dwordx4 v[96:99], v1, s[40:43], s45 offen offset:0 nt
  s_waitcnt vmcnt(5)
  buffer_load_dwordx4 v[100:103], v1, s[40:43], s45 offen offset:1024 nt
  s_add_u32 s61, s61, 10240
  s_and_b32 s61, s61, 65535
  s_add_u32 s62, s62, 65536
  s_and_b32 s62, s62, 0x1fffff
  s_add_u32 s45, s61, s62
  s_waitcnt vmcnt(5)
  buffer_load_dwordx4 v[104:107], v1, s[40:43], s45 offen offset:0 nt
  s_waitcnt vmcnt(5)
  buffer_load_dwordx4 v[108:111], v1, s[40:43], s45 offen offset:1024 nt
  s_add_u32 s61, s61, 10240
  s_and_b32 s61, s61, 65535
  s_add_u32 s62, s62, 65536
  s_and_b32 s62, s62, 0x1fffff
  s_add_u32 s45, s61, s62
  s_waitcnt vmcnt(5)
  buffer_load_dwordx4 v[112:115], v1, s[40:43], s45 offen offset:0 nt
  s_waitcnt vmcnt(5)
  buffer_load_dwordx4 v[116:119], v1, s[40:43], s45 offen offset:1024 nt
  s_add_u32 s61, s61, 10240
  s_and_b32 s61, s61, 65535
  s_add_u32 s62, s62, 65536
  s_and_b32 s62, s62, 0x1fffff
  s_add_u32 s45, s61, s62
  s_waitcnt vmcnt(5)
  buffer_load_dwordx4 v[120:123], v1, s[40:43], s45 offen offset:0 nt
  s_waitcnt vmcnt(5)
  buffer_load_dwordx4 v[124:127], v1, s[40:43], s45 offen offset:1024 nt
  s_add_u32 s61, s61, 10240
  s_and_b32 s61, s61, 65535
  s_add_u32 s62, s62, 65536
  s_and_b32 s62, s62, 0x1fffff
  s_add_u32 s45, s61, s62
  v_lshrrev_b32 v13, 4, v0
  v_and_b32 v14, 15, v0
  v_and_b32 v15, 3, v14
  v_lshlrev_b32 v15, 10, v15
  v_lshrrev_b32 v10, 2, v14
  v_lshl_add_u32 v15, v10, 8, v15
  v_add_u32 v15, s46, v15
  v_add_u32 v6, 0, v13
  v_xor_b32 v6, v6, v14
  v_lshl_add_u32 v6, v6, 4, v15
  v_add_u32 v7, 4, v13
  v_xor_b32 v7, v7, v14
  v_lshl_add_u32 v7, v7, 4, v15
  v_add_u32 v8, 8, v13
  v_xor_b32 v8, v8, v14
  v_lshl_add_u32 v8, v8, 4, v15
  v_add_u32 v9, 12, v13
  v_xor_b32 v9, v9, v14
  v_lshl_add_u32 v9, v9, 4, v15
  s_mov_b32 s47, 0x05040100
  s_mov_b32 s48, 0x07060302
  s_mov_b32 s50, 0x3db504f3
  s_mov_b32 s51, s50
  s_mov_b32 s52, 0x3fb8aa3b
  s_mov_b32 s53, s52
  v_and_b32 v15, 3, v0
  v_lshlrev_b32 v15, 8, v15
  v_lshl_add_u32 v15, v13, 4, v15
  v_add_u32 v92, 131072, v15
  s_add_u32 m0, s46, 8192
  s_waitcnt vmcnt(5)
  buffer_load_dwordx4 v2, s[36:39], s44 offen offset:0 nt lds
  s_waitcnt vmcnt(5)
  buffer_load_dwordx4 v3, s[36:39], s44 offen offset:1024 nt lds
  s_add_u32 s59, s59, 10240
  s_and_b32 s59, s59, 65535
  s_add_u32 s60, s60, 65536
  s_and_b32 s60, s60, 0x1fffff
  s_add_u32 s44, s59, s60
  s_add_u32 m0, s46, 10240
  s_waitcnt vmcnt(5)
  buffer_load_dwordx4 v4, s[36:39], s44 offen offset:0 nt lds
  s_waitcnt vmcnt(5)
  buffer_load_dwordx4 v5, s[36:39], s44 offen offset:1024 nt lds
  s_add_u32 s59, s59, 10240
  s_and_b32 s59, s59, 65535
  s_add_u32 s60, s60, 65536
  s_and_b32 s60, s60, 0x1fffff
  s_add_u32 s44, s59, s60
  s_add_u32 m0, s46, 12288
  s_waitcnt vmcnt(5)
  buffer_load_dwordx4 v2, s[36:39], s44 offen offset:0 nt lds
  s_waitcnt vmcnt(5)
  buffer_load_dwordx4 v3, s[36:39], s44 offen offset:1024 nt lds
  s_add_u32 s59, s59, 10240
  s_and_b32 s59, s59, 65535
  s_add_u32 s60, s60, 65536
  s_and_b32 s60, s60, 0x1fffff
  s_add_u32 s44, s59, s60
  s_add_u32 m0, s46, 14336
  s_waitcnt vmcnt(5)
  buffer_load_dwordx4 v4, s[36:39], s44 offen offset:0 nt lds
  s_waitcnt vmcnt(5)
  buffer_load_dwordx4 v5, s[36:39], s44 offen offset:1024 nt lds
  s_add_u32 s59, s59, 10240
  s_and_b32 s59, s59, 65535
  s_add_u32 s60, s60, 65536
  s_and_b32 s60, s60, 0x1fffff
  s_add_u32 s44, s59, s60
  s_waitcnt vmcnt(5)
  buffer_load_dwordx4 v[128:131], v1, s[40:43], s45 offen offset:0 nt
  s_waitcnt vmcnt(5)
  buffer_load_dwordx4 v[132:135], v1, s[40:43], s45 offen offset:1024 nt
  s_add_u32 s61, s61, 10240
  s_and_b32 s61, s61, 65535
  s_add_u32 s62, s62, 65536
  s_and_b32 s62, s62, 0x1fffff
  s_add_u32 s45, s61, s62
  s_waitcnt vmcnt(5)
  buffer_load_dwordx4 v[136:139], v1, s[40:43], s45 offen offset:0 nt
  s_waitcnt vmcnt(5)
  buffer_load_dwordx4 v[140:143], v1, s[40:43], s45 offen offset:1024 nt
  s_add_u32 s61, s61, 10240
  s_and_b32 s61, s61, 65535
  s_add_u32 s62, s62, 65536
  s_and_b32 s62, s62, 0x1fffff
  s_add_u32 s45, s61, s62
  s_waitcnt vmcnt(5)
  buffer_load_dwordx4 v[144:147], v1, s[40:43], s45 offen offset:0 nt
  s_waitcnt vmcnt(5)
  buffer_load_dwordx4 v[148:151], v1, s[40:43], s45 offen offset:1024 nt
  s_add_u32 s61, s61, 10240
  s_and_b32 s61, s61, 65535
  s_add_u32 s62, s62, 65536
  s_and_b32 s62, s62, 0x1fffff
  s_add_u32 s45, s61, s62
  s_waitcnt vmcnt(5)
  buffer_load_dwordx4 v[152:155], v1, s[40:43], s45 offen offset:0 nt
  s_waitcnt vmcnt(5)
  buffer_load_dwordx4 v[156:159], v1, s[40:43], s45 offen offset:1024 nt
  s_add_u32 s61, s61, 10240
  s_and_b32 s61, s61, 65535
  s_add_u32 s62, s62, 65536
  s_and_b32 s62, s62, 0x1fffff
  s_add_u32 s45, s61, s62
  s_add_u32 m0, s46, 16384
  s_waitcnt vmcnt(5)
  buffer_load_dwordx4 v2, s[36:39], s44 offen offset:0 nt lds
  s_waitcnt vmcnt(5)
  buffer_load_dwordx4 v3, s[36:39], s44 offen offset:1024 nt lds
  s_add_u32 s59, s59, 10240
  s_and_b32 s59, s59, 65535
  s_add_u32 s60, s60, 65536
  s_and_b32 s60, s60, 0x1fffff
  s_add_u32 s44, s59, s60
  s_add_u32 m0, s46, 18432
  s_waitcnt vmcnt(5)
  buffer_load_dwordx4 v4, s[36:39], s44 offen offset:0 nt lds
  s_waitcnt vmcnt(5)
  buffer_load_dwordx4 v5, s[36:39], s44 offen offset:1024 nt lds
  s_add_u32 s59, s59, 10240
  s_and_b32 s59, s59, 65535
  s_add_u32 s60, s60, 65536
  s_and_b32 s60, s60, 0x1fffff
  s_add_u32 s44, s59, s60
  s_add_u32 m0, s46, 20480
  s_waitcnt vmcnt(5)
  buffer_load_dwordx4 v2, s[36:39], s44 offen offset:0 nt lds
  s_waitcnt vmcnt(5)
  buffer_load_dwordx4 v3, s[36:39], s44 offen offset:1024 nt lds
  s_add_u32 s59, s59, 10240
  s_and_b32 s59, s59, 65535
  s_add_u32 s60, s60, 65536
  s_and_b32 s60, s60, 0x1fffff
  s_add_u32 s44, s59, s60
  s_add_u32 m0, s46, 22528
  s_waitcnt vmcnt(5)
  buffer_load_dwordx4 v4, s[36:39], s44 offen offset:0 nt lds
  s_waitcnt vmcnt(5)
  buffer_load_dwordx4 v5, s[36:39], s44 offen offset:1024 nt lds
  s_add_u32 s59, s59, 10240
  s_and_b32 s59, s59, 65535
  s_add_u32 s60, s60, 65536
  s_and_b32 s60, s60, 0x1fffff
  s_add_u32 s44, s59, s60
  s_waitcnt vmcnt(5)
  buffer_load_dwordx4 v[160:163], v1, s[40:43], s45 offen offset:0 nt
  s_waitcnt vmcnt(5)
  buffer_load_dwordx4 v[164:167], v1, s[40:43], s45 offen offset:1024 nt
  s_add_u32 s61, s61, 10240
  s_and_b32 s61, s61, 65535
  s_add_u32 s62, s62, 65536
  s_and_b32 s62, s62, 0x1fffff
  s_add_u32 s45, s61, s62
  s_waitcnt vmcnt(5)
  buffer_load_dwordx4 v[168:171], v1, s[40:43], s45 offen offset:0 nt
  s_waitcnt vmcnt(5)
  buffer_load_dwordx4 v[172:175], v1, s[40:43], s45 offen offset:1024 nt
  s_add_u32 s61, s61, 10240
  s_and_b32 s61, s61, 65535
  s_add_u32 s62, s62, 65536
  s_and_b32 s62, s62, 0x1fffff
  s_add_u32 s45, s61, s62
  s_waitcnt vmcnt(5)
  buffer_load_dwordx4 v[176:179], v1, s[40:43], s45 offen offset:0 nt
  s_waitcnt vmcnt(5)
  buffer_load_dwordx4 v[180:183], v1, s[40:43], s45 offen offset:1024 nt
  s_add_u32 s61, s61, 10240
  s_and_b32 s61, s61, 65535
  s_add_u32 s62, s62, 65536
  s_and_b32 s62, s62, 0x1fffff
  s_add_u32 s45, s61, s62
  s_waitcnt vmcnt(5)
  buffer_load_dwordx4 v[184:187], v1, s[40:43], s45 offen offset:0 nt
  s_waitcnt vmcnt(5)
  buffer_load_dwordx4 v[188:191], v1, s[40:43], s45 offen offset:1024 nt
  s_add_u32 s61, s61, 10240
  s_and_b32 s61, s61, 65535
  s_add_u32 s62, s62, 65536
  s_and_b32 s62, s62, 0x1fffff
  s_add_u32 s45, s61, s62
  s_add_u32 m0, s46, 24576
  s_waitcnt vmcnt(5)
  buffer_load_dwordx4 v2, s[36:39], s44 offen offset:0 nt lds
  s_waitcnt vmcnt(5)
  buffer_load_dwordx4 v3, s[36:39], s44 offen offset:1024 nt lds
  s_add_u32 s59, s59, 10240
  s_and_b32 s59, s59, 65535
  s_add_u32 s60, s60, 65536
  s_and_b32 s60, s60, 0x1fffff
  s_add_u32 s44, s59, s60
  s_add_u32 m0, s46, 26624
  s_waitcnt vmcnt(5)
  buffer_load_dwordx4 v4, s[36:39], s44 offen offset:0 nt lds
  s_waitcnt vmcnt(5)
  buffer_load_dwordx4 v5, s[36:39], s44 offen offset:1024 nt lds
  s_add_u32 s59, s59, 10240
  s_and_b32 s59, s59, 65535
  s_add_u32 s60, s60, 65536
  s_and_b32 s60, s60, 0x1fffff
  s_add_u32 s44, s59, s60
  s_add_u32 m0, s46, 28672
  s_waitcnt vmcnt(5)
  buffer_load_dwordx4 v2, s[36:39], s44 offen offset:0 nt lds
  s_waitcnt vmcnt(5)
  buffer_load_dwordx4 v3, s[36:39], s44 offen offset:1024 nt lds
  s_add_u32 s59, s59, 10240
  s_and_b32 s59, s59, 65535
  s_add_u32 s60, s60, 65536
  s_and_b32 s60, s60, 0x1fffff
  s_add_u32 s44, s59, s60
  s_add_u32 m0, s46, 30720
  s_waitcnt vmcnt(5)
  buffer_load_dwordx4 v4, s[36:39], s44 offen offset:0 nt lds
  s_waitcnt vmcnt(5)
  buffer_load_dwordx4 v5, s[36:39], s44 offen offset:1024 nt lds
  s_add_u32 s59, s59, 10240
  s_and_b32 s59, s59, 65535
  s_add_u32 s60, s60, 65536
  s_and_b32 s60, s60, 0x1fffff
  s_add_u32 s44, s59, s60
  s_waitcnt vmcnt(5)
  buffer_load_dwordx4 v[192:195], v1, s[40:43], s45 offen offset:0 nt
  s_waitcnt vmcnt(5)
  buffer_load_dwordx4 v[196:199], v1, s[40:43], s45 offen offset:1024 nt
  s_add_u32 s61, s61, 10240
  s_and_b32 s61, s61, 65535
  s_add_u32 s62, s62, 65536
  s_and_b32 s62, s62, 0x1fffff
  s_add_u32 s45, s61, s62
  s_waitcnt vmcnt(5)
  buffer_load_dwordx4 v[200:203], v1, s[40:43], s45 offen offset:0 nt
  s_waitcnt vmcnt(5)
  buffer_load_dwordx4 v[204:207], v1, s[40:43], s45 offen offset:1024 nt
  s_add_u32 s61, s61, 10240
  s_and_b32 s61, s61, 65535
  s_add_u32 s62, s62, 65536
  s_and_b32 s62, s62, 0x1fffff
  s_add_u32 s45, s61, s62
  s_waitcnt vmcnt(5)
  buffer_load_dwordx4 v[208:211], v1, s[40:43], s45 offen offset:0 nt
  s_waitcnt vmcnt(5)
  buffer_load_dwordx4 v[212:215], v1, s[40:43], s45 offen offset:1024 nt
  s_add_u32 s61, s61, 10240
  s_and_b32 s61, s61, 65535
  s_add_u32 s62, s62, 65536
  s_and_b32 s62, s62, 0x1fffff
  s_add_u32 s45, s61, s62
  s_waitcnt vmcnt(5)
  buffer_load_dwordx4 v[216:219], v1, s[40:43], s45 offen offset:0 nt
  s_waitcnt vmcnt(5)
  buffer_load_dwordx4 v[220:223], v1, s[40:43], s45 offen offset:1024 nt
  s_add_u32 s61, s61, 10240
  s_and_b32 s61, s61, 65535
  s_add_u32 s62, s62, 65536
  s_and_b32 s62, s62, 0x1fffff
  s_add_u32 s45, s61, s62
  s_waitcnt vmcnt(5)
  buffer_load_dwordx4 v[224:227], v1, s[40:43], s45 offen offset:0 nt
  s_waitcnt vmcnt(5)
  buffer_load_dwordx4 v[228:231], v1, s[40:43], s45 offen offset:1024 nt
  s_add_u32 s61, s61, 10240
  s_and_b32 s61, s61, 65535
  s_add_u32 s62, s62, 65536
  s_and_b32 s62, s62, 0x1fffff
  s_add_u32 s45, s61, s62
  s_waitcnt vmcnt(5)
  buffer_load_dwordx4 v[232:235], v1, s[40:43], s45 offen offset:0 nt
  s_waitcnt vmcnt(5)
  buffer_load_dwordx4 v[236:239], v1, s[40:43], s45 offen offset:1024 nt
  s_add_u32 s61, s61, 10240
  s_and_b32 s61, s61, 65535
  s_add_u32 s62, s62, 65536
  s_and_b32 s62, s62, 0x1fffff
  s_add_u32 s45, s61, s62
  s_waitcnt vmcnt(5)
  buffer_load_dwordx4 v[240:243], v1, s[40:43], s45 offen offset:0 nt
  s_waitcnt vmcnt(5)
  buffer_load_dwordx4 v[244:247], v1, s[40:43], s45 offen offset:1024 nt
  s_add_u32 s61, s61, 10240
  s_and_b32 s61, s61, 65535
  s_add_u32 s62, s62, 65536
  s_and_b32 s62, s62, 0x1fffff
  s_add_u32 s45, s61, s62
  s_waitcnt vmcnt(5)
  buffer_load_dwordx4 v[248:251], v1, s[40:43], s45 offen offset:0 nt
  s_waitcnt vmcnt(5)
  buffer_load_dwordx4 v[252:255], v1, s[40:43], s45 offen offset:1024 nt
  s_add_u32 s61, s61, 10240
  s_and_b32 s61, s61, 65535
  s_add_u32 s62, s62, 65536
  s_and_b32 s62, s62, 0x1fffff
  s_add_u32 s45, s61, s62
  v_mov_b32 v13, 157888
  s_mov_b32 s57, 1
  s_branch L_lw_1_go
L_lw_1:
  s_add_u32 s57, s57, 1
  s_cmp_gt_u32 s57, 400000
  s_cbranch_scc1 L_end
L_lw_1_go:
  ds_read_b32 v14, v13
  s_waitcnt lgkmcnt(0)
  v_readfirstlane_b32 s58, v14
  s_nop 0
  s_cmp_ge_u32 s58, 1
  s_cbranch_scc0 L_lw_1
  ds_read_b128 v[16:19], v92 offset:0
  ds_read_b128 v[20:23], v92 offset:64
  ds_read_b128 v[24:27], v92 offset:128
  ds_read_b128 v[28:31], v92 offset:192
  s_waitcnt lgkmcnt(0)
  s_waitcnt vmcnt(63)
  ds_read_b128 v[64:67], v6 offset:0
  ds_read_b128 v[68:71], v7 offset:0
  ds_read_b128 v[72:75], v8 offset:0
  ds_read_b128 v[76:79], v9 offset:0
  s_waitcnt lgkmcnt(3)
  v_mfma_f32_16x16x32_bf16 v[80:83], v[64:67], v[16:19], 0
  ds_read_b128 v[64:67], v6 offset:4096
  s_waitcnt lgkmcnt(3)
  v_mfma_f32_16x16x32_bf16 v[80:83], v[68:71], v[20:23], v[80:83]
  ds_read_b128 v[68:71], v7 offset:4096
  s_waitcnt lgkmcnt(3)
  v_mfma_f32_16x16x32_bf16 v[80:83], v[72:75], v[24:27], v[80:83]
  ds_read_b128 v[72:75], v8 offset:4096
  s_waitcnt lgkmcnt(3)
  v_mfma_f32_16x16x32_bf16 v[80:83], v[76:79], v[28:31], v[80:83]
  ds_read_b128 v[76:79], v9 offset:4096
  s_waitcnt lgkmcnt(3)
  v_mfma_f32_16x16x32_bf16 v[84:87], v[64:67], v[16:19], 0
  s_waitcnt lgkmcnt(2)
  v_mfma_f32_16x16x32_bf16 v[84:87], v[68:71], v[20:23], v[84:87]
  s_waitcnt lgkmcnt(1)
  v_mfma_f32_16x16x32_bf16 v[84:87], v[72:75], v[24:27], v[84:87]
  s_waitcnt lgkmcnt(0)
  v_mfma_f32_16x16x32_bf16 v[84:87], v[76:79], v[28:31], v[84:87]
  v_cvt_pk_bf16_f32 v92, v80, v81
  v_cvt_pk_bf16_f32 v93, v82, v83
  s_nop 5
  v_cvt_pk_bf16_f32 v94, v84, v85
  v_cvt_pk_bf16_f32 v95, v86, v87
  v_lshlrev_b32 v80, 16, v92
  v_and_b32 v81, 0xffff0000, v92
  v_lshlrev_b32 v82, 16, v93
  v_and_b32 v83, 0xffff0000, v93
  v_lshlrev_b32 v84, 16, v94
  v_and_b32 v85, 0xffff0000, v94
  v_lshlrev_b32 v86, 16, v95
  v_and_b32 v87, 0xffff0000, v95
  v_pk_mul_f32 v[80:81], v[80:81], s[50:51] op_sel_hi:[1,0]
  v_pk_mul_f32 v[82:83], v[82:83], s[50:51] op_sel_hi:[1,0]
  v_pk_mul_f32 v[84:85], v[84:85], s[50:51] op_sel_hi:[1,0]
  v_pk_mul_f32 v[86:87], v[86:87], s[50:51] op_sel_hi:[1,0]
  v_cvt_pk_bf16_f32 v92, v80, v81
  v_cvt_pk_bf16_f32 v93, v82, v83
  v_cvt_pk_bf16_f32 v94, v84, v85
  v_cvt_pk_bf16_f32 v95, v86, v87
  v_lshlrev_b32 v80, 16, v92
  v_and_b32 v81, 0xffff0000, v92
  v_lshlrev_b32 v82, 16, v93
  v_and_b32 v83, 0xffff0000, v93
  v_lshlrev_b32 v84, 16, v94
  v_and_b32 v85, 0xffff0000, v94
  v_lshlrev_b32 v86, 16, v95
  v_and_b32 v87, 0xffff0000, v95
  v_max3_f32 v13, v80, v81, v82
  v_max3_f32 v14, v83, v84, v85
  v_max3_f32 v13, v13, v86, v87
  v_max_f32 v13, v13, v14
  v_mov_b32 v14, v13
  s_nop 1
  v_permlane32_swap_b32 v13, v14
  v_max_f32 v13, v13, v14
  v_mov_b32 v14, v13
  s_nop 1
  v_permlane16_swap_b32 v13, v14
  v_max_f32 v13, v13, v14
  v_mul_f32 v10, s52, v13
  v_pk_fma_f32 v[80:81], v[80:81], s[52:53], v[10:11] op_sel_hi:[1,0,0] neg_lo:[0,0,1] neg_hi:[0,0,1]
  v_pk_fma_f32 v[82:83], v[82:83], s[52:53], v[10:11] op_sel_hi:[1,0,0] neg_lo:[0,0,1] neg_hi:[0,0,1]
  v_pk_fma_f32 v[84:85], v[84:85], s[52:53], v[10:11] op_sel_hi:[1,0,0] neg_lo:[0,0,1] neg_hi:[0,0,1]
  v_pk_fma_f32 v[86:87], v[86:87], s[52:53], v[10:11] op_sel_hi:[1,0,0] neg_lo:[0,0,1] neg_hi:[0,0,1]
  v_exp_f32 v80, v80
  v_exp_f32 v81, v81
  v_exp_f32 v82, v82
  v_exp_f32 v83, v83
  v_exp_f32 v84, v84
  v_exp_f32 v85, v85
  v_exp_f32 v86, v86
  v_exp_f32 v87, v87
  v_cvt_pk_bf16_f32 v88, v80, v81
  v_cvt_pk_bf16_f32 v89, v82, v83
  v_cvt_pk_bf16_f32 v90, v84, v85
  v_cvt_pk_bf16_f32 v91, v86, v87
  v_lshlrev_b32 v80, 16, v88
  v_and_b32 v81, 0xffff0000, v88
  v_lshlrev_b32 v82, 16, v89
  v_and_b32 v83, 0xffff0000, v89
  v_lshlrev_b32 v84, 16, v90
  v_and_b32 v85, 0xffff0000, v90
  v_lshlrev_b32 v86, 16, v91
  v_and_b32 v87, 0xffff0000, v91
  v_pk_add_f32 v[80:81], v[80:81], v[82:83]
  v_pk_add_f32 v[84:85], v[84:85], v[86:87]
  v_pk_add_f32 v[80:81], v[80:81], v[84:85]
  v_add_f32 v11, v80, v81
  s_waitcnt vmcnt(56)
  v_perm_b32 v64, v100, v96, s47
  v_perm_b32 v65, v108, v104, s47
  v_perm_b32 v66, v116, v112, s47
  v_perm_b32 v67, v124, v120, s47
  v_perm_b32 v68, v100, v96, s48
  v_perm_b32 v69, v108, v104, s48
  v_perm_b32 v70, v116, v112, s48
  v_perm_b32 v71, v124, v120, s48
  v_mfma_f32_16x16x32_bf16 v[32:35], v[64:67], v[88:91], 0
  v_perm_b32 v72, v101, v97, s47
  v_perm_b32 v73, v109, v105, s47
  v_perm_b32 v74, v117, v113, s47
  v_perm_b32 v75, v125, v121, s47
  v_mfma_f32_16x16x32_bf16 v[36:39], v[68:71], v[88:91], 0
  v_perm_b32 v76, v101, v97, s48
  v_perm_b32 v77, v109, v105, s48
  v_perm_b32 v78, v117, v113, s48
  v_perm_b32 v79, v125, v121, s48
  v_mfma_f32_16x16x32_bf16 v[40:43], v[72:75], v[88:91], 0
  v_perm_b32 v64, v102, v98, s47
  v_perm_b32 v65, v110, v106, s47
  v_perm_b32 v66, v118, v114, s47
  v_perm_b32 v67, v126, v122, s47
  v_mfma_f32_16x16x32_bf16 v[44:47], v[76:79], v[88:91], 0
  v_perm_b32 v68, v102, v98, s48
  v_perm_b32 v69, v110, v106, s48
  v_perm_b32 v70, v118, v114, s48
  v_perm_b32 v71, v126, v122, s48
  v_mfma_f32_16x16x32_bf16 v[48:51], v[64:67], v[88:91], 0
  v_perm_b32 v72, v103, v99, s47
  v_perm_b32 v73, v111, v107, s47
  v_perm_b32 v74, v119, v115, s47
  v_perm_b32 v75, v127, v123, s47
  v_mfma_f32_16x16x32_bf16 v[52:55], v[68:71], v[88:91], 0
  v_perm_b32 v76, v103, v99, s48
  v_perm_b32 v77, v111, v107, s48
  v_perm_b32 v78, v119, v115, s48
  v_perm_b32 v79, v127, v123, s48
  v_mfma_f32_16x16x32_bf16 v[56:59], v[72:75], v[88:91], 0
  s_nop 0
  v_mfma_f32_16x16x32_bf16 v[60:63], v[76:79], v[88:91], 0
  s_add_u32 m0, s46, 0
  s_waitcnt vmcnt(7)
  buffer_load_dwordx4 v2, s[36:39], s44 offen offset:0 nt lds
  s_waitcnt vmcnt(7)
  buffer_load_dwordx4 v3, s[36:39], s44 offen offset:1024 nt lds
  s_add_u32 s59, s59, 10240
  s_and_b32 s59, s59, 65535
  s_add_u32 s60, s60, 65536
  s_and_b32 s60, s60, 0x1fffff
  s_add_u32 s44, s59, s60
  s_add_u32 m0, s46, 2048
  s_waitcnt vmcnt(7)
  buffer_load_dwordx4 v4, s[36:39], s44 offen offset:0 nt lds
  s_waitcnt vmcnt(7)
  buffer_load_dwordx4 v5, s[36:39], s44 offen offset:1024 nt lds
  s_add_u32 s59, s59, 10240
  s_and_b32 s59, s59, 65535
  s_add_u32 s60, s60, 65536
  s_and_b32 s60, s60, 0x1fffff
  s_add_u32 s44, s59, s60
  s_add_u32 m0, s46, 4096
  s_waitcnt vmcnt(7)
  buffer_load_dwordx4 v2, s[36:39], s44 offen offset:0 nt lds
  s_waitcnt vmcnt(7)
  buffer_load_dwordx4 v3, s[36:39], s44 offen offset:1024 nt lds
  s_add_u32 s59, s59, 10240
  s_and_b32 s59, s59, 65535
  s_add_u32 s60, s60, 65536
  s_and_b32 s60, s60, 0x1fffff
  s_add_u32 s44, s59, s60
  s_add_u32 m0, s46, 6144
  s_waitcnt vmcnt(7)
  buffer_load_dwordx4 v4, s[36:39], s44 offen offset:0 nt lds
  s_waitcnt vmcnt(7)
  buffer_load_dwordx4 v5, s[36:39], s44 offen offset:1024 nt lds
  s_add_u32 s59, s59, 10240
  s_and_b32 s59, s59, 65535
  s_add_u32 s60, s60, 65536
  s_and_b32 s60, s60, 0x1fffff
  s_add_u32 s44, s59, s60
  s_waitcnt vmcnt(56)
  ds_read_b128 v[64:67], v6 offset:8192
  ds_read_b128 v[68:71], v7 offset:8192
  ds_read_b128 v[72:75], v8 offset:8192
  ds_read_b128 v[76:79], v9 offset:8192
  s_waitcnt lgkmcnt(3)
  v_mfma_f32_16x16x32_bf16 v[80:83], v[64:67], v[16:19], 0
  ds_read_b128 v[64:67], v6 offset:12288
  s_waitcnt lgkmcnt(3)
  v_mfma_f32_16x16x32_bf16 v[80:83], v[68:71], v[20:23], v[80:83]
  ds_read_b128 v[68:71], v7 offset:12288
  s_waitcnt lgkmcnt(3)
  v_mfma_f32_16x16x32_bf16 v[80:83], v[72:75], v[24:27], v[80:83]
  ds_read_b128 v[72:75], v8 offset:12288
  s_waitcnt lgkmcnt(3)
  v_mfma_f32_16x16x32_bf16 v[80:83], v[76:79], v[28:31], v[80:83]
  ds_read_b128 v[76:79], v9 offset:12288
  s_waitcnt lgkmcnt(3)
  v_mfma_f32_16x16x32_bf16 v[84:87], v[64:67], v[16:19], 0
  s_waitcnt lgkmcnt(2)
  v_mfma_f32_16x16x32_bf16 v[84:87], v[68:71], v[20:23], v[84:87]
  s_waitcnt lgkmcnt(1)
  v_mfma_f32_16x16x32_bf16 v[84:87], v[72:75], v[24:27], v[84:87]
  s_waitcnt lgkmcnt(0)
  v_mfma_f32_16x16x32_bf16 v[84:87], v[76:79], v[28:31], v[84:87]
  v_cvt_pk_bf16_f32 v92, v80, v81
  v_cvt_pk_bf16_f32 v93, v82, v83
  s_nop 5
  v_cvt_pk_bf16_f32 v94, v84, v85
  v_cvt_pk_bf16_f32 v95, v86, v87
  v_lshlrev_b32 v80, 16, v92
  v_and_b32 v81, 0xffff0000, v92
  v_lshlrev_b32 v82, 16, v93
  v_and_b32 v83, 0xffff0000, v93
  v_lshlrev_b32 v84, 16, v94
  v_and_b32 v85, 0xffff0000, v94
  v_lshlrev_b32 v86, 16, v95
  v_and_b32 v87, 0xffff0000, v95
  v_pk_mul_f32 v[80:81], v[80:81], s[50:51] op_sel_hi:[1,0]
  v_pk_mul_f32 v[82:83], v[82:83], s[50:51] op_sel_hi:[1,0]
  v_pk_mul_f32 v[84:85], v[84:85], s[50:51] op_sel_hi:[1,0]
  v_pk_mul_f32 v[86:87], v[86:87], s[50:51] op_sel_hi:[1,0]
  v_cvt_pk_bf16_f32 v92, v80, v81
  v_cvt_pk_bf16_f32 v93, v82, v83
  v_cvt_pk_bf16_f32 v94, v84, v85
  v_cvt_pk_bf16_f32 v95, v86, v87
  v_lshlrev_b32 v80, 16, v92
  v_and_b32 v81, 0xffff0000, v92
  v_lshlrev_b32 v82, 16, v93
  v_and_b32 v83, 0xffff0000, v93
  v_lshlrev_b32 v84, 16, v94
  v_and_b32 v85, 0xffff0000, v94
  v_lshlrev_b32 v86, 16, v95
  v_and_b32 v87, 0xffff0000, v95
  v_max3_f32 v13, v80, v81, v82
  v_max3_f32 v14, v83, v84, v85
  v_max3_f32 v13, v13, v86, v87
  v_max_f32 v13, v13, v14
  v_mov_b32 v14, v13
  s_nop 1
  v_permlane32_swap_b32 v13, v14
  v_max_f32 v13, v13, v14
  v_mov_b32 v14, v13
  s_nop 1
  v_permlane16_swap_b32 v13, v14
  v_max_f32 v13, v13, v14
  v_mul_f32 v13, s52, v13
  v_max_f32 v13, v13, v10
  v_sub_f32 v12, v10, v13
  v_mov_b32 v10, v13
  v_exp_f32 v12, v12
  v_pk_fma_f32 v[80:81], v[80:81], s[52:53], v[10:11] op_sel_hi:[1,0,0] neg_lo:[0,0,1] neg_hi:[0,0,1]
  v_pk_fma_f32 v[82:83], v[82:83], s[52:53], v[10:11] op_sel_hi:[1,0,0] neg_lo:[0,0,1] neg_hi:[0,0,1]
  v_pk_fma_f32 v[84:85], v[84:85], s[52:53], v[10:11] op_sel_hi:[1,0,0] neg_lo:[0,0,1] neg_hi:[0,0,1]
  v_pk_fma_f32 v[86:87], v[86:87], s[52:53], v[10:11] op_sel_hi:[1,0,0] neg_lo:[0,0,1] neg_hi:[0,0,1]
  v_exp_f32 v80, v80
  v_exp_f32 v81, v81
  v_exp_f32 v82, v82
  v_exp_f32 v83, v83
  v_exp_f32 v84, v84
  v_exp_f32 v85, v85
  v_exp_f32 v86, v86
  v_exp_f32 v87, v87
  v_pk_mul_f32 v[32:33], v[32:33], v[12:13] op_sel_hi:[1,0]
  v_pk_mul_f32 v[34:35], v[34:35], v[12:13] op_sel_hi:[1,0]
  v_pk_mul_f32 v[36:37], v[36:37], v[12:13] op_sel_hi:[1,0]
  v_pk_mul_f32 v[38:39], v[38:39], v[12:13] op_sel_hi:[1,0]
  v_pk_mul_f32 v[40:41], v[40:41], v[12:13] op_sel_hi:[1,0]
  v_pk_mul_f32 v[42:43], v[42:43], v[12:13] op_sel_hi:[1,0]
  v_pk_mul_f32 v[44:45], v[44:45], v[12:13] op_sel_hi:[1,0]
  v_pk_mul_f32 v[46:47], v[46:47], v[12:13] op_sel_hi:[1,0]
  v_pk_mul_f32 v[48:49], v[48:49], v[12:13] op_sel_hi:[1,0]
  v_pk_mul_f32 v[50:51], v[50:51], v[12:13] op_sel_hi:[1,0]
  v_pk_mul_f32 v[52:53], v[52:53], v[12:13] op_sel_hi:[1,0]
  v_pk_mul_f32 v[54:55], v[54:55], v[12:13] op_sel_hi:[1,0]
  v_pk_mul_f32 v[56:57], v[56:57], v[12:13] op_sel_hi:[1,0]
  v_pk_mul_f32 v[58:59], v[58:59], v[12:13] op_sel_hi:[1,0]
  v_pk_mul_f32 v[60:61], v[60:61], v[12:13] op_sel_hi:[1,0]
  v_pk_mul_f32 v[62:63], v[62:63], v[12:13] op_sel_hi:[1,0]
L_nors_2:
  v_cvt_pk_bf16_f32 v88, v80, v81
  v_cvt_pk_bf16_f32 v89, v82, v83
  v_cvt_pk_bf16_f32 v90, v84, v85
  v_cvt_pk_bf16_f32 v91, v86, v87
  v_lshlrev_b32 v80, 16, v88
  v_and_b32 v81, 0xffff0000, v88
  v_lshlrev_b32 v82, 16, v89
  v_and_b32 v83, 0xffff0000, v89
  v_lshlrev_b32 v84, 16, v90
  v_and_b32 v85, 0xffff0000, v90
  v_lshlrev_b32 v86, 16, v91
  v_and_b32 v87, 0xffff0000, v91
  v_pk_add_f32 v[80:81], v[80:81], v[82:83]
  v_pk_add_f32 v[84:85], v[84:85], v[86:87]
  v_pk_add_f32 v[80:81], v[80:81], v[84:85]
  v_add_f32 v80, v80, v81
  v_fma_f32 v11, v11, v12, v80
  s_waitcnt vmcnt(48)
  v_perm_b32 v64, v132, v128, s47
  v_perm_b32 v65, v140, v136, s47
  v_perm_b32 v66, v148, v144, s47
  v_perm_b32 v67, v156, v152, s47
  v_perm_b32 v68, v132, v128, s48
  v_perm_b32 v69, v140, v136, s48
  v_perm_b32 v70, v148, v144, s48
  v_perm_b32 v71, v156, v152, s48
  v_mfma_f32_16x16x32_bf16 v[32:35], v[64:67], v[88:91], v[32:35]
  v_perm_b32 v72, v133, v129, s47
  v_perm_b32 v73, v141, v137, s47
  v_perm_b32 v74, v149, v145, s47
  v_perm_b32 v75, v157, v153, s47
  v_mfma_f32_16x16x32_bf16 v[36:39], v[68:71], v[88:91], v[36:39]
  v_perm_b32 v76, v133, v129, s48
  v_perm_b32 v77, v141, v137, s48
  v_perm_b32 v78, v149, v145, s48
  v_perm_b32 v79, v157, v153, s48
  v_mfma_f32_16x16x32_bf16 v[40:43], v[72:75], v[88:91], v[40:43]
  v_perm_b32 v64, v134, v130, s47
  v_perm_b32 v65, v142, v138, s47
  v_perm_b32 v66, v150, v146, s47
  v_perm_b32 v67, v158, v154, s47
  v_mfma_f32_16x16x32_bf16 v[44:47], v[76:79], v[88:91], v[44:47]
  v_perm_b32 v68, v134, v130, s48
  v_perm_b32 v69, v142, v138, s48
  v_perm_b32 v70, v150, v146, s48
  v_perm_b32 v71, v158, v154, s48
  v_mfma_f32_16x16x32_bf16 v[48:51], v[64:67], v[88:91], v[48:51]
  v_perm_b32 v72, v135, v131, s47
  v_perm_b32 v73, v143, v139, s47
  v_perm_b32 v74, v151, v147, s47
  v_perm_b32 v75, v159, v155, s47
  v_mfma_f32_16x16x32_bf16 v[52:55], v[68:71], v[88:91], v[52:55]
  v_perm_b32 v76, v135, v131, s48
  v_perm_b32 v77, v143, v139, s48
  v_perm_b32 v78, v151, v147, s48
  v_perm_b32 v79, v159, v155, s48
  v_mfma_f32_16x16x32_bf16 v[56:59], v[72:75], v[88:91], v[56:59]
  s_nop 0
  v_mfma_f32_16x16x32_bf16 v[60:63], v[76:79], v[88:91], v[60:63]
  s_waitcnt vmcnt(7)
  buffer_load_dwordx4 v[96:99], v1, s[40:43], s45 offen offset:0 nt
  s_waitcnt vmcnt(7)
  buffer_load_dwordx4 v[100:103], v1, s[40:43], s45 offen offset:1024 nt
  s_add_u32 s61, s61, 10240
  s_and_b32 s61, s61, 65535
  s_add_u32 s62, s62, 65536
  s_and_b32 s62, s62, 0x1fffff
  s_add_u32 s45, s61, s62
  s_waitcnt vmcnt(7)
  buffer_load_dwordx4 v[104:107], v1, s[40:43], s45 offen offset:0 nt
  s_waitcnt vmcnt(7)
  buffer_load_dwordx4 v[108:111], v1, s[40:43], s45 offen offset:1024 nt
  s_add_u32 s61, s61, 10240
  s_and_b32 s61, s61, 65535
  s_add_u32 s62, s62, 65536
  s_and_b32 s62, s62, 0x1fffff
  s_add_u32 s45, s61, s62
  s_waitcnt vmcnt(7)
  buffer_load_dwordx4 v[112:115], v1, s[40:43], s45 offen offset:0 nt
  s_waitcnt vmcnt(7)
  buffer_load_dwordx4 v[116:119], v1, s[40:43], s45 offen offset:1024 nt
  s_add_u32 s61, s61, 10240
  s_and_b32 s61, s61, 65535
  s_add_u32 s62, s62, 65536
  s_and_b32 s62, s62, 0x1fffff
  s_add_u32 s45, s61, s62
  s_waitcnt vmcnt(7)
  buffer_load_dwordx4 v[120:123], v1, s[40:43], s45 offen offset:0 nt
  s_waitcnt vmcnt(7)
  buffer_load_dwordx4 v[124:127], v1, s[40:43], s45 offen offset:1024 nt
  s_add_u32 s61, s61, 10240
  s_and_b32 s61, s61, 65535
  s_add_u32 s62, s62, 65536
  s_and_b32 s62, s62, 0x1fffff
  s_add_u32 s45, s61, s62
  s_waitcnt vmcnt(48)
  ds_read_b128 v[64:67], v6 offset:16384
  ds_read_b128 v[68:71], v7 offset:16384
  ds_read_b128 v[72:75], v8 offset:16384
  ds_read_b128 v[76:79], v9 offset:16384
  s_waitcnt lgkmcnt(3)
  v_mfma_f32_16x16x32_bf16 v[80:83], v[64:67], v[16:19], 0
  ds_read_b128 v[64:67], v6 offset:20480
  s_waitcnt lgkmcnt(3)
  v_mfma_f32_16x16x32_bf16 v[80:83], v[68:71], v[20:23], v[80:83]
  ds_read_b128 v[68:71], v7 offset:20480
  s_waitcnt lgkmcnt(3)
  v_mfma_f32_16x16x32_bf16 v[80:83], v[72:75], v[24:27], v[80:83]
  ds_read_b128 v[72:75], v8 offset:20480
  s_waitcnt lgkmcnt(3)
  v_mfma_f32_16x16x32_bf16 v[80:83], v[76:79], v[28:31], v[80:83]
  ds_read_b128 v[76:79], v9 offset:20480
  s_waitcnt lgkmcnt(3)
  v_mfma_f32_16x16x32_bf16 v[84:87], v[64:67], v[16:19], 0
  s_waitcnt lgkmcnt(2)
  v_mfma_f32_16x16x32_bf16 v[84:87], v[68:71], v[20:23], v[84:87]
  s_waitcnt lgkmcnt(1)
  v_mfma_f32_16x16x32_bf16 v[84:87], v[72:75], v[24:27], v[84:87]
  s_waitcnt lgkmcnt(0)
  v_mfma_f32_16x16x32_bf16 v[84:87], v[76:79], v[28:31], v[84:87]
  v_cvt_pk_bf16_f32 v92, v80, v81
  v_cvt_pk_bf16_f32 v93, v82, v83
  s_nop 5
  v_cvt_pk_bf16_f32 v94, v84, v85
  v_cvt_pk_bf16_f32 v95, v86, v87
  v_lshlrev_b32 v80, 16, v92
  v_and_b32 v81, 0xffff0000, v92
  v_lshlrev_b32 v82, 16, v93
  v_and_b32 v83, 0xffff0000, v93
  v_lshlrev_b32 v84, 16, v94
  v_and_b32 v85, 0xffff0000, v94
  v_lshlrev_b32 v86, 16, v95
  v_and_b32 v87, 0xffff0000, v95
  v_pk_mul_f32 v[80:81], v[80:81], s[50:51] op_sel_hi:[1,0]
  v_pk_mul_f32 v[82:83], v[82:83], s[50:51] op_sel_hi:[1,0]
  v_pk_mul_f32 v[84:85], v[84:85], s[50:51] op_sel_hi:[1,0]
  v_pk_mul_f32 v[86:87], v[86:87], s[50:51] op_sel_hi:[1,0]
  v_cvt_pk_bf16_f32 v92, v80, v81
  v_cvt_pk_bf16_f32 v93, v82, v83
  v_cvt_pk_bf16_f32 v94, v84, v85
  v_cvt_pk_bf16_f32 v95, v86, v87
  v_lshlrev_b32 v80, 16, v92
  v_and_b32 v81, 0xffff0000, v92
  v_lshlrev_b32 v82, 16, v93
  v_and_b32 v83, 0xffff0000, v93
  v_lshlrev_b32 v84, 16, v94
  v_and_b32 v85, 0xffff0000, v94
  v_lshlrev_b32 v86, 16, v95
  v_and_b32 v87, 0xffff0000, v95
  v_max3_f32 v13, v80, v81, v82
  v_max3_f32 v14, v83, v84, v85
  v_max3_f32 v13, v13, v86, v87
  v_max_f32 v13, v13, v14
  v_mov_b32 v14, v13
  s_nop 1
  v_permlane32_swap_b32 v13, v14
  v_max_f32 v13, v13, v14
  v_mov_b32 v14, v13
  s_nop 1
  v_permlane16_swap_b32 v13, v14
  v_max_f32 v13, v13, v14
  v_mul_f32 v13, s52, v13
  v_max_f32 v13, v13, v10
  v_sub_f32 v12, v10, v13
  v_mov_b32 v10, v13
  v_exp_f32 v12, v12
  v_pk_fma_f32 v[80:81], v[80:81], s[52:53], v[10:11] op_sel_hi:[1,0,0] neg_lo:[0,0,1] neg_hi:[0,0,1]
  v_pk_fma_f32 v[82:83], v[82:83], s[52:53], v[10:11] op_sel_hi:[1,0,0] neg_lo:[0,0,1] neg_hi:[0,0,1]
  v_pk_fma_f32 v[84:85], v[84:85], s[52:53], v[10:11] op_sel_hi:[1,0,0] neg_lo:[0,0,1] neg_hi:[0,0,1]
  v_pk_fma_f32 v[86:87], v[86:87], s[52:53], v[10:11] op_sel_hi:[1,0,0] neg_lo:[0,0,1] neg_hi:[0,0,1]
  v_exp_f32 v80, v80
  v_exp_f32 v81, v81
  v_exp_f32 v82, v82
  v_exp_f32 v83, v83
  v_exp_f32 v84, v84
  v_exp_f32 v85, v85
  v_exp_f32 v86, v86
  v_exp_f32 v87, v87
  v_pk_mul_f32 v[32:33], v[32:33], v[12:13] op_sel_hi:[1,0]
  v_pk_mul_f32 v[34:35], v[34:35], v[12:13] op_sel_hi:[1,0]
  v_pk_mul_f32 v[36:37], v[36:37], v[12:13] op_sel_hi:[1,0]
  v_pk_mul_f32 v[38:39], v[38:39], v[12:13] op_sel_hi:[1,0]
  v_pk_mul_f32 v[40:41], v[40:41], v[12:13] op_sel_hi:[1,0]
  v_pk_mul_f32 v[42:43], v[42:43], v[12:13] op_sel_hi:[1,0]
  v_pk_mul_f32 v[44:45], v[44:45], v[12:13] op_sel_hi:[1,0]
  v_pk_mul_f32 v[46:47], v[46:47], v[12:13] op_sel_hi:[1,0]
  v_pk_mul_f32 v[48:49], v[48:49], v[12:13] op_sel_hi:[1,0]
  v_pk_mul_f32 v[50:51], v[50:51], v[12:13] op_sel_hi:[1,0]
  v_pk_mul_f32 v[52:53], v[52:53], v[12:13] op_sel_hi:[1,0]
  v_pk_mul_f32 v[54:55], v[54:55], v[12:13] op_sel_hi:[1,0]
  v_pk_mul_f32 v[56:57], v[56:57], v[12:13] op_sel_hi:[1,0]
  v_pk_mul_f32 v[58:59], v[58:59], v[12:13] op_sel_hi:[1,0]
  v_pk_mul_f32 v[60:61], v[60:61], v[12:13] op_sel_hi:[1,0]
  v_pk_mul_f32 v[62:63], v[62:63], v[12:13] op_sel_hi:[1,0]
L_nors_3:
  v_cvt_pk_bf16_f32 v88, v80, v81
  v_cvt_pk_bf16_f32 v89, v82, v83
  v_cvt_pk_bf16_f32 v90, v84, v85
  v_cvt_pk_bf16_f32 v91, v86, v87
  v_lshlrev_b32 v80, 16, v88
  v_and_b32 v81, 0xffff0000, v88
  v_lshlrev_b32 v82, 16, v89
  v_and_b32 v83, 0xffff0000, v89
  v_lshlrev_b32 v84, 16, v90
  v_and_b32 v85, 0xffff0000, v90
  v_lshlrev_b32 v86, 16, v91
  v_and_b32 v87, 0xffff0000, v91
  v_pk_add_f32 v[80:81], v[80:81], v[82:83]
  v_pk_add_f32 v[84:85], v[84:85], v[86:87]
  v_pk_add_f32 v[80:81], v[80:81], v[84:85]
  v_add_f32 v80, v80, v81
  v_fma_f32 v11, v11, v12, v80
  s_waitcnt vmcnt(40)
  v_perm_b32 v64, v164, v160, s47
  v_perm_b32 v65, v172, v168, s47
  v_perm_b32 v66, v180, v176, s47
  v_perm_b32 v67, v188, v184, s47
  v_perm_b32 v68, v164, v160, s48
  v_perm_b32 v69, v172, v168, s48
  v_perm_b32 v70, v180, v176, s48
  v_perm_b32 v71, v188, v184, s48
  v_mfma_f32_16x16x32_bf16 v[32:35], v[64:67], v[88:91], v[32:35]
  v_perm_b32 v72, v165, v161, s47
  v_perm_b32 v73, v173, v169, s47
  v_perm_b32 v74, v181, v177, s47
  v_perm_b32 v75, v189, v185, s47
  v_mfma_f32_16x16x32_bf16 v[36:39], v[68:71], v[88:91], v[36:39]
  v_perm_b32 v76, v165, v161, s48
  v_perm_b32 v77, v173, v169, s48
  v_perm_b32 v78, v181, v177, s48
  v_perm_b32 v79, v189, v185, s48
  v_mfma_f32_16x16x32_bf16 v[40:43], v[72:75], v[88:91], v[40:43]
  v_perm_b32 v64, v166, v162, s47
  v_perm_b32 v65, v174, v170, s47
  v_perm_b32 v66, v182, v178, s47
  v_perm_b32 v67, v190, v186, s47
  v_mfma_f32_16x16x32_bf16 v[44:47], v[76:79], v[88:91], v[44:47]
  v_perm_b32 v68, v166, v162, s48
  v_perm_b32 v69, v174, v170, s48
  v_perm_b32 v70, v182, v178, s48
  v_perm_b32 v71, v190, v186, s48
  v_mfma_f32_16x16x32_bf16 v[48:51], v[64:67], v[88:91], v[48:51]
  v_perm_b32 v72, v167, v163, s47
  v_perm_b32 v73, v175, v171, s47
  v_perm_b32 v74, v183, v179, s47
  v_perm_b32 v75, v191, v187, s47
  v_mfma_f32_16x16x32_bf16 v[52:55], v[68:71], v[88:91], v[52:55]
  v_perm_b32 v76, v167, v163, s48
  v_perm_b32 v77, v175, v171, s48
  v_perm_b32 v78, v183, v179, s48
  v_perm_b32 v79, v191, v187, s48
  v_mfma_f32_16x16x32_bf16 v[56:59], v[72:75], v[88:91], v[56:59]
  s_nop 0
  v_mfma_f32_16x16x32_bf16 v[60:63], v[76:79], v[88:91], v[60:63]
  s_add_u32 m0, s46, 8192
  s_waitcnt vmcnt(7)
  buffer_load_dwordx4 v2, s[36:39], s44 offen offset:0 nt lds
  s_waitcnt vmcnt(7)
  buffer_load_dwordx4 v3, s[36:39], s44 offen offset:1024 nt lds
  s_add_u32 s59, s59, 10240
  s_and_b32 s59, s59, 65535
  s_add_u32 s60, s60, 65536
  s_and_b32 s60, s60, 0x1fffff
  s_add_u32 s44, s59, s60
  s_add_u32 m0, s46, 10240
  s_waitcnt vmcnt(7)
  buffer_load_dwordx4 v4, s[36:39], s44 offen offset:0 nt lds
  s_waitcnt vmcnt(7)
  buffer_load_dwordx4 v5, s[36:39], s44 offen offset:1024 nt lds
  s_add_u32 s59, s59, 10240
  s_and_b32 s59, s59, 65535
  s_add_u32 s60, s60, 65536
  s_and_b32 s60, s60, 0x1fffff
  s_add_u32 s44, s59, s60
  s_add_u32 m0, s46, 12288
  s_waitcnt vmcnt(7)
  buffer_load_dwordx4 v2, s[36:39], s44 offen offset:0 nt lds
  s_waitcnt vmcnt(7)
  buffer_load_dwordx4 v3, s[36:39], s44 offen offset:1024 nt lds
  s_add_u32 s59, s59, 10240
  s_and_b32 s59, s59, 65535
  s_add_u32 s60, s60, 65536
  s_and_b32 s60, s60, 0x1fffff
  s_add_u32 s44, s59, s60
  s_add_u32 m0, s46, 14336
  s_waitcnt vmcnt(7)
  buffer_load_dwordx4 v4, s[36:39], s44 offen offset:0 nt lds
  s_waitcnt vmcnt(7)
  buffer_load_dwordx4 v5, s[36:39], s44 offen offset:1024 nt lds
  s_add_u32 s59, s59, 10240
  s_and_b32 s59, s59, 65535
  s_add_u32 s60, s60, 65536
  s_and_b32 s60, s60, 0x1fffff
  s_add_u32 s44, s59, s60
  s_waitcnt vmcnt(40)
  ds_read_b128 v[64:67], v6 offset:24576
  ds_read_b128 v[68:71], v7 offset:24576
  ds_read_b128 v[72:75], v8 offset:24576
  ds_read_b128 v[76:79], v9 offset:24576
  s_waitcnt lgkmcnt(3)
  v_mfma_f32_16x16x32_bf16 v[80:83], v[64:67], v[16:19], 0
  ds_read_b128 v[64:67], v6 offset:28672
  s_waitcnt lgkmcnt(3)
  v_mfma_f32_16x16x32_bf16 v[80:83], v[68:71], v[20:23], v[80:83]
  ds_read_b128 v[68:71], v7 offset:28672
  s_waitcnt lgkmcnt(3)
  v_mfma_f32_16x16x32_bf16 v[80:83], v[72:75], v[24:27], v[80:83]
  ds_read_b128 v[72:75], v8 offset:28672
  s_waitcnt lgkmcnt(3)
  v_mfma_f32_16x16x32_bf16 v[80:83], v[76:79], v[28:31], v[80:83]
  ds_read_b128 v[76:79], v9 offset:28672
  s_waitcnt lgkmcnt(3)
  v_mfma_f32_16x16x32_bf16 v[84:87], v[64:67], v[16:19], 0
  s_waitcnt lgkmcnt(2)
  v_mfma_f32_16x16x32_bf16 v[84:87], v[68:71], v[20:23], v[84:87]
  s_waitcnt lgkmcnt(1)
  v_mfma_f32_16x16x32_bf16 v[84:87], v[72:75], v[24:27], v[84:87]
  s_waitcnt lgkmcnt(0)
  v_mfma_f32_16x16x32_bf16 v[84:87], v[76:79], v[28:31], v[84:87]
  v_cvt_pk_bf16_f32 v92, v80, v81
  v_cvt_pk_bf16_f32 v93, v82, v83
  s_nop 5
  v_cvt_pk_bf16_f32 v94, v84, v85
  v_cvt_pk_bf16_f32 v95, v86, v87
  v_lshlrev_b32 v80, 16, v92
  v_and_b32 v81, 0xffff0000, v92
  v_lshlrev_b32 v82, 16, v93
  v_and_b32 v83, 0xffff0000, v93
  v_lshlrev_b32 v84, 16, v94
  v_and_b32 v85, 0xffff0000, v94
  v_lshlrev_b32 v86, 16, v95
  v_and_b32 v87, 0xffff0000, v95
  v_pk_mul_f32 v[80:81], v[80:81], s[50:51] op_sel_hi:[1,0]
  v_pk_mul_f32 v[82:83], v[82:83], s[50:51] op_sel_hi:[1,0]
  v_pk_mul_f32 v[84:85], v[84:85], s[50:51] op_sel_hi:[1,0]
  v_pk_mul_f32 v[86:87], v[86:87], s[50:51] op_sel_hi:[1,0]
  v_cvt_pk_bf16_f32 v92, v80, v81
  v_cvt_pk_bf16_f32 v93, v82, v83
  v_cvt_pk_bf16_f32 v94, v84, v85
  v_cvt_pk_bf16_f32 v95, v86, v87
  v_lshlrev_b32 v80, 16, v92
  v_and_b32 v81, 0xffff0000, v92
  v_lshlrev_b32 v82, 16, v93
  v_and_b32 v83, 0xffff0000, v93
  v_lshlrev_b32 v84, 16, v94
  v_and_b32 v85, 0xffff0000, v94
  v_lshlrev_b32 v86, 16, v95
  v_and_b32 v87, 0xffff0000, v95
  v_max3_f32 v13, v80, v81, v82
  v_max3_f32 v14, v83, v84, v85
  v_max3_f32 v13, v13, v86, v87
  v_max_f32 v13, v13, v14
  v_mov_b32 v14, v13
  s_nop 1
  v_permlane32_swap_b32 v13, v14
  v_max_f32 v13, v13, v14
  v_mov_b32 v14, v13
  s_nop 1
  v_permlane16_swap_b32 v13, v14
  v_max_f32 v13, v13, v14
  v_mul_f32 v13, s52, v13
  v_max_f32 v13, v13, v10
  v_sub_f32 v12, v10, v13
  v_mov_b32 v10, v13
  v_exp_f32 v12, v12
  v_pk_fma_f32 v[80:81], v[80:81], s[52:53], v[10:11] op_sel_hi:[1,0,0] neg_lo:[0,0,1] neg_hi:[0,0,1]
  v_pk_fma_f32 v[82:83], v[82:83], s[52:53], v[10:11] op_sel_hi:[1,0,0] neg_lo:[0,0,1] neg_hi:[0,0,1]
  v_pk_fma_f32 v[84:85], v[84:85], s[52:53], v[10:11] op_sel_hi:[1,0,0] neg_lo:[0,0,1] neg_hi:[0,0,1]
  v_pk_fma_f32 v[86:87], v[86:87], s[52:53], v[10:11] op_sel_hi:[1,0,0] neg_lo:[0,0,1] neg_hi:[0,0,1]
  v_exp_f32 v80, v80
  v_exp_f32 v81, v81
  v_exp_f32 v82, v82
  v_exp_f32 v83, v83
  v_exp_f32 v84, v84
  v_exp_f32 v85, v85
  v_exp_f32 v86, v86
  v_exp_f32 v87, v87
  v_pk_mul_f32 v[32:33], v[32:33], v[12:13] op_sel_hi:[1,0]
  v_pk_mul_f32 v[34:35], v[34:35], v[12:13] op_sel_hi:[1,0]
  v_pk_mul_f32 v[36:37], v[36:37], v[12:13] op_sel_hi:[1,0]
  v_pk_mul_f32 v[38:39], v[38:39], v[12:13] op_sel_hi:[1,0]
  v_pk_mul_f32 v[40:41], v[40:41], v[12:13] op_sel_hi:[1,0]
  v_pk_mul_f32 v[42:43], v[42:43], v[12:13] op_sel_hi:[1,0]
  v_pk_mul_f32 v[44:45], v[44:45], v[12:13] op_sel_hi:[1,0]
  v_pk_mul_f32 v[46:47], v[46:47], v[12:13] op_sel_hi:[1,0]
  v_pk_mul_f32 v[48:49], v[48:49], v[12:13] op_sel_hi:[1,0]
  v_pk_mul_f32 v[50:51], v[50:51], v[12:13] op_sel_hi:[1,0]
  v_pk_mul_f32 v[52:53], v[52:53], v[12:13] op_sel_hi:[1,0]
  v_pk_mul_f32 v[54:55], v[54:55], v[12:13] op_sel_hi:[1,0]
  v_pk_mul_f32 v[56:57], v[56:57], v[12:13] op_sel_hi:[1,0]
  v_pk_mul_f32 v[58:59], v[58:59], v[12:13] op_sel_hi:[1,0]
  v_pk_mul_f32 v[60:61], v[60:61], v[12:13] op_sel_hi:[1,0]
  v_pk_mul_f32 v[62:63], v[62:63], v[12:13] op_sel_hi:[1,0]
L_nors_4:
  v_cvt_pk_bf16_f32 v88, v80, v81
  v_cvt_pk_bf16_f32 v89, v82, v83
  v_cvt_pk_bf16_f32 v90, v84, v85
  v_cvt_pk_bf16_f32 v91, v86, v87
  v_lshlrev_b32 v80, 16, v88
  v_and_b32 v81, 0xffff0000, v88
  v_lshlrev_b32 v82, 16, v89
  v_and_b32 v83, 0xffff0000, v89
  v_lshlrev_b32 v84, 16, v90
  v_and_b32 v85, 0xffff0000, v90
  v_lshlrev_b32 v86, 16, v91
  v_and_b32 v87, 0xffff0000, v91
  v_pk_add_f32 v[80:81], v[80:81], v[82:83]
  v_pk_add_f32 v[84:85], v[84:85], v[86:87]
  v_pk_add_f32 v[80:81], v[80:81], v[84:85]
  v_add_f32 v80, v80, v81
  v_fma_f32 v11, v11, v12, v80
  s_waitcnt vmcnt(32)
  v_perm_b32 v64, v196, v192, s47
  v_perm_b32 v65, v204, v200, s47
  v_perm_b32 v66, v212, v208, s47
  v_perm_b32 v67, v220, v216, s47
  v_perm_b32 v68, v196, v192, s48
  v_perm_b32 v69, v204, v200, s48
  v_perm_b32 v70, v212, v208, s48
  v_perm_b32 v71, v220, v216, s48
  v_mfma_f32_16x16x32_bf16 v[32:35], v[64:67], v[88:91], v[32:35]
  v_perm_b32 v72, v197, v193, s47
  v_perm_b32 v73, v205, v201, s47
  v_perm_b32 v74, v213, v209, s47
  v_perm_b32 v75, v221, v217, s47
  v_mfma_f32_16x16x32_bf16 v[36:39], v[68:71], v[88:91], v[36:39]
  v_perm_b32 v76, v197, v193, s48
  v_perm_b32 v77, v205, v201, s48
  v_perm_b32 v78, v213, v209, s48
  v_perm_b32 v79, v221, v217, s48
  v_mfma_f32_16x16x32_bf16 v[40:43], v[72:75], v[88:91], v[40:43]
  v_perm_b32 v64, v198, v194, s47
  v_perm_b32 v65, v206, v202, s47
  v_perm_b32 v66, v214, v210, s47
  v_perm_b32 v67, v222, v218, s47
  v_mfma_f32_16x16x32_bf16 v[44:47], v[76:79], v[88:91], v[44:47]
  v_perm_b32 v68, v198, v194, s48
  v_perm_b32 v69, v206, v202, s48
  v_perm_b32 v70, v214, v210, s48
  v_perm_b32 v71, v222, v218, s48
  v_mfma_f32_16x16x32_bf16 v[48:51], v[64:67], v[88:91], v[48:51]
  v_perm_b32 v72, v199, v195, s47
  v_perm_b32 v73, v207, v203, s47
  v_perm_b32 v74, v215, v211, s47
  v_perm_b32 v75, v223, v219, s47
  v_mfma_f32_16x16x32_bf16 v[52:55], v[68:71], v[88:91], v[52:55]
  v_perm_b32 v76, v199, v195, s48
  v_perm_b32 v77, v207, v203, s48
  v_perm_b32 v78, v215, v211, s48
  v_perm_b32 v79, v223, v219, s48
  v_mfma_f32_16x16x32_bf16 v[56:59], v[72:75], v[88:91], v[56:59]
  s_nop 0
  v_mfma_f32_16x16x32_bf16 v[60:63], v[76:79], v[88:91], v[60:63]
  s_waitcnt vmcnt(7)
  buffer_load_dwordx4 v[128:131], v1, s[40:43], s45 offen offset:0 nt
  s_waitcnt vmcnt(7)
  buffer_load_dwordx4 v[132:135], v1, s[40:43], s45 offen offset:1024 nt
  s_add_u32 s61, s61, 10240
  s_and_b32 s61, s61, 65535
  s_add_u32 s62, s62, 65536
  s_and_b32 s62, s62, 0x1fffff
  s_add_u32 s45, s61, s62
  s_waitcnt vmcnt(7)
  buffer_load_dwordx4 v[136:139], v1, s[40:43], s45 offen offset:0 nt
  s_waitcnt vmcnt(7)
  buffer_load_dwordx4 v[140:143], v1, s[40:43], s45 offen offset:1024 nt
  s_add_u32 s61, s61, 10240
  s_and_b32 s61, s61, 65535
  s_add_u32 s62, s62, 65536
  s_and_b32 s62, s62, 0x1fffff
  s_add_u32 s45, s61, s62
  s_waitcnt vmcnt(7)
  buffer_load_dwordx4 v[144:147], v1, s[40:43], s45 offen offset:0 nt
  s_waitcnt vmcnt(7)
  buffer_load_dwordx4 v[148:151], v1, s[40:43], s45 offen offset:1024 nt
  s_add_u32 s61, s61, 10240
  s_and_b32 s61, s61, 65535
  s_add_u32 s62, s62, 65536
  s_and_b32 s62, s62, 0x1fffff
  s_add_u32 s45, s61, s62
  s_waitcnt vmcnt(7)
  buffer_load_dwordx4 v[152:155], v1, s[40:43], s45 offen offset:0 nt
  s_waitcnt vmcnt(7)
  buffer_load_dwordx4 v[156:159], v1, s[40:43], s45 offen offset:1024 nt
  s_add_u32 s61, s61, 10240
  s_and_b32 s61, s61, 65535
  s_add_u32 s62, s62, 65536
  s_and_b32 s62, s62, 0x1fffff
  s_add_u32 s45, s61, s62
  s_waitcnt vmcnt(24)
  ds_read_b128 v[64:67], v6 offset:0
  ds_read_b128 v[68:71], v7 offset:0
  ds_read_b128 v[72:75], v8 offset:0
  ds_read_b128 v[76:79], v9 offset:0
  s_waitcnt lgkmcnt(3)
  v_mfma_f32_16x16x32_bf16 v[80:83], v[64:67], v[16:19], 0
  ds_read_b128 v[64:67], v6 offset:4096
  s_waitcnt lgkmcnt(3)
  v_mfma_f32_16x16x32_bf16 v[80:83], v[68:71], v[20:23], v[80:83]
  ds_read_b128 v[68:71], v7 offset:4096
  s_waitcnt lgkmcnt(3)
  v_mfma_f32_16x16x32_bf16 v[80:83], v[72:75], v[24:27], v[80:83]
  ds_read_b128 v[72:75], v8 offset:4096
  s_waitcnt lgkmcnt(3)
  v_mfma_f32_16x16x32_bf16 v[80:83], v[76:79], v[28:31], v[80:83]
  ds_read_b128 v[76:79], v9 offset:4096
  s_waitcnt lgkmcnt(3)
  v_mfma_f32_16x16x32_bf16 v[84:87], v[64:67], v[16:19], 0
  s_waitcnt lgkmcnt(2)
  v_mfma_f32_16x16x32_bf16 v[84:87], v[68:71], v[20:23], v[84:87]
  s_waitcnt lgkmcnt(1)
  v_mfma_f32_16x16x32_bf16 v[84:87], v[72:75], v[24:27], v[84:87]
  s_waitcnt lgkmcnt(0)
  v_mfma_f32_16x16x32_bf16 v[84:87], v[76:79], v[28:31], v[84:87]
  v_cvt_pk_bf16_f32 v92, v80, v81
  v_cvt_pk_bf16_f32 v93, v82, v83
  s_nop 5
  v_cvt_pk_bf16_f32 v94, v84, v85
  v_cvt_pk_bf16_f32 v95, v86, v87
  v_lshlrev_b32 v80, 16, v92
  v_and_b32 v81, 0xffff0000, v92
  v_lshlrev_b32 v82, 16, v93
  v_and_b32 v83, 0xffff0000, v93
  v_lshlrev_b32 v84, 16, v94
  v_and_b32 v85, 0xffff0000, v94
  v_lshlrev_b32 v86, 16, v95
  v_and_b32 v87, 0xffff0000, v95
  v_pk_mul_f32 v[80:81], v[80:81], s[50:51] op_sel_hi:[1,0]
  v_pk_mul_f32 v[82:83], v[82:83], s[50:51] op_sel_hi:[1,0]
  v_pk_mul_f32 v[84:85], v[84:85], s[50:51] op_sel_hi:[1,0]
  v_pk_mul_f32 v[86:87], v[86:87], s[50:51] op_sel_hi:[1,0]
  v_cvt_pk_bf16_f32 v92, v80, v81
  v_cvt_pk_bf16_f32 v93, v82, v83
  v_cvt_pk_bf16_f32 v94, v84, v85
  v_cvt_pk_bf16_f32 v95, v86, v87
  v_lshlrev_b32 v80, 16, v92
  v_and_b32 v81, 0xffff0000, v92
  v_lshlrev_b32 v82, 16, v93
  v_and_b32 v83, 0xffff0000, v93
  v_lshlrev_b32 v84, 16, v94
  v_and_b32 v85, 0xffff0000, v94
  v_lshlrev_b32 v86, 16, v95
  v_and_b32 v87, 0xffff0000, v95
  v_max3_f32 v13, v80, v81, v82
  v_max3_f32 v14, v83, v84, v85
  v_max3_f32 v13, v13, v86, v87
  v_max_f32 v13, v13, v14
  v_mov_b32 v14, v13
  s_nop 1
  v_permlane32_swap_b32 v13, v14
  v_max_f32 v13, v13, v14
  v_mov_b32 v14, v13
  s_nop 1
  v_permlane16_swap_b32 v13, v14
  v_max_f32 v13, v13, v14
  v_mul_f32 v13, s52, v13
  v_max_f32 v13, v13, v10
  v_sub_f32 v12, v10, v13
  v_mov_b32 v10, v13
  v_exp_f32 v12, v12
  v_pk_fma_f32 v[80:81], v[80:81], s[52:53], v[10:11] op_sel_hi:[1,0,0] neg_lo:[0,0,1] neg_hi:[0,0,1]
  v_pk_fma_f32 v[82:83], v[82:83], s[52:53], v[10:11] op_sel_hi:[1,0,0] neg_lo:[0,0,1] neg_hi:[0,0,1]
  v_pk_fma_f32 v[84:85], v[84:85], s[52:53], v[10:11] op_sel_hi:[1,0,0] neg_lo:[0,0,1] neg_hi:[0,0,1]
  v_pk_fma_f32 v[86:87], v[86:87], s[52:53], v[10:11] op_sel_hi:[1,0,0] neg_lo:[0,0,1] neg_hi:[0,0,1]
  v_exp_f32 v80, v80
  v_exp_f32 v81, v81
  v_exp_f32 v82, v82
  v_exp_f32 v83, v83
  v_exp_f32 v84, v84
  v_exp_f32 v85, v85
  v_exp_f32 v86, v86
  v_exp_f32 v87, v87
  v_pk_mul_f32 v[32:33], v[32:33], v[12:13] op_sel_hi:[1,0]
  v_pk_mul_f32 v[34:35], v[34:35], v[12:13] op_sel_hi:[1,0]
  v_pk_mul_f32 v[36:37], v[36:37], v[12:13] op_sel_hi:[1,0]
  v_pk_mul_f32 v[38:39], v[38:39], v[12:13] op_sel_hi:[1,0]
  v_pk_mul_f32 v[40:41], v[40:41], v[12:13] op_sel_hi:[1,0]
  v_pk_mul_f32 v[42:43], v[42:43], v[12:13] op_sel_hi:[1,0]
  v_pk_mul_f32 v[44:45], v[44:45], v[12:13] op_sel_hi:[1,0]
  v_pk_mul_f32 v[46:47], v[46:47], v[12:13] op_sel_hi:[1,0]
  v_pk_mul_f32 v[48:49], v[48:49], v[12:13] op_sel_hi:[1,0]
  v_pk_mul_f32 v[50:51], v[50:51], v[12:13] op_sel_hi:[1,0]
  v_pk_mul_f32 v[52:53], v[52:53], v[12:13] op_sel_hi:[1,0]
  v_pk_mul_f32 v[54:55], v[54:55], v[12:13] op_sel_hi:[1,0]
  v_pk_mul_f32 v[56:57], v[56:57], v[12:13] op_sel_hi:[1,0]
  v_pk_mul_f32 v[58:59], v[58:59], v[12:13] op_sel_hi:[1,0]
  v_pk_mul_f32 v[60:61], v[60:61], v[12:13] op_sel_hi:[1,0]
  v_pk_mul_f32 v[62:63], v[62:63], v[12:13] op_sel_hi:[1,0]
L_nors_5:
  v_cvt_pk_bf16_f32 v88, v80, v81
  v_cvt_pk_bf16_f32 v89, v82, v83
  v_cvt_pk_bf16_f32 v90, v84, v85
  v_cvt_pk_bf16_f32 v91, v86, v87
  v_lshlrev_b32 v80, 16, v88
  v_and_b32 v81, 0xffff0000, v88
  v_lshlrev_b32 v82, 16, v89
  v_and_b32 v83, 0xffff0000, v89
  v_lshlrev_b32 v84, 16, v90
  v_and_b32 v85, 0xffff0000, v90
  v_lshlrev_b32 v86, 16, v91
  v_and_b32 v87, 0xffff0000, v91
  v_pk_add_f32 v[80:81], v[80:81], v[82:83]
  v_pk_add_f32 v[84:85], v[84:85], v[86:87]
  v_pk_add_f32 v[80:81], v[80:81], v[84:85]
  v_add_f32 v80, v80, v81
  v_fma_f32 v11, v11, v12, v80
  s_waitcnt vmcnt(32)
  v_perm_b32 v64, v228, v224, s47
  v_perm_b32 v65, v236, v232, s47
  v_perm_b32 v66, v244, v240, s47
  v_perm_b32 v67, v252, v248, s47
  v_perm_b32 v68, v228, v224, s48
  v_perm_b32 v69, v236, v232, s48
  v_perm_b32 v70, v244, v240, s48
  v_perm_b32 v71, v252, v248, s48
  v_mfma_f32_16x16x32_bf16 v[32:35], v[64:67], v[88:91], v[32:35]
  v_perm_b32 v72, v229, v225, s47
  v_perm_b32 v73, v237, v233, s47
  v_perm_b32 v74, v245, v241, s47
  v_perm_b32 v75, v253, v249, s47
  v_mfma_f32_16x16x32_bf16 v[36:39], v[68:71], v[88:91], v[36:39]
  v_perm_b32 v76, v229, v225, s48
  v_perm_b32 v77, v237, v233, s48
  v_perm_b32 v78, v245, v241, s48
  v_perm_b32 v79, v253, v249, s48
  v_mfma_f32_16x16x32_bf16 v[40:43], v[72:75], v[88:91], v[40:43]
  v_perm_b32 v64, v230, v226, s47
  v_perm_b32 v65, v238, v234, s47
  v_perm_b32 v66, v246, v242, s47
  v_perm_b32 v67, v254, v250, s47
  v_mfma_f32_16x16x32_bf16 v[44:47], v[76:79], v[88:91], v[44:47]
  v_perm_b32 v68, v230, v226, s48
  v_perm_b32 v69, v238, v234, s48
  v_perm_b32 v70, v246, v242, s48
  v_perm_b32 v71, v254, v250, s48
  v_mfma_f32_16x16x32_bf16 v[48:51], v[64:67], v[88:91], v[48:51]
  v_perm_b32 v72, v231, v227, s47
  v_perm_b32 v73, v239, v235, s47
  v_perm_b32 v74, v247, v243, s47
  v_perm_b32 v75, v255, v251, s47
  v_mfma_f32_16x16x32_bf16 v[52:55], v[68:71], v[88:91], v[52:55]
  v_perm_b32 v76, v231, v227, s48
  v_perm_b32 v77, v239, v235, s48
  v_perm_b32 v78, v247, v243, s48
  v_perm_b32 v79, v255, v251, s48
  v_mfma_f32_16x16x32_bf16 v[56:59], v[72:75], v[88:91], v[56:59]
  s_nop 0
  v_mfma_f32_16x16x32_bf16 v[60:63], v[76:79], v[88:91], v[60:63]
  s_add_u32 m0, s46, 16384
  s_waitcnt vmcnt(7)
  buffer_load_dwordx4 v2, s[36:39], s44 offen offset:0 nt lds
  s_waitcnt vmcnt(7)
  buffer_load_dwordx4 v3, s[36:39], s44 offen offset:1024 nt lds
  s_add_u32 s59, s59, 10240
  s_and_b32 s59, s59, 65535
  s_add_u32 s60, s60, 65536
  s_and_b32 s60, s60, 0x1fffff
  s_add_u32 s44, s59, s60
  s_add_u32 m0, s46, 18432
  s_waitcnt vmcnt(7)
  buffer_load_dwordx4 v4, s[36:39], s44 offen offset:0 nt lds
  s_waitcnt vmcnt(7)
  buffer_load_dwordx4 v5, s[36:39], s44 offen offset:1024 nt lds
  s_add_u32 s59, s59, 10240
  s_and_b32 s59, s59, 65535
  s_add_u32 s60, s60, 65536
  s_and_b32 s60, s60, 0x1fffff
  s_add_u32 s44, s59, s60
  s_add_u32 m0, s46, 20480
  s_waitcnt vmcnt(7)
  buffer_load_dwordx4 v2, s[36:39], s44 offen offset:0 nt lds
  s_waitcnt vmcnt(7)
  buffer_load_dwordx4 v3, s[36:39], s44 offen offset:1024 nt lds
  s_add_u32 s59, s59, 10240
  s_and_b32 s59, s59, 65535
  s_add_u32 s60, s60, 65536
  s_and_b32 s60, s60, 0x1fffff
  s_add_u32 s44, s59, s60
  s_add_u32 m0, s46, 22528
  s_waitcnt vmcnt(7)
  buffer_load_dwordx4 v4, s[36:39], s44 offen offset:0 nt lds
  s_waitcnt vmcnt(7)
  buffer_load_dwordx4 v5, s[36:39], s44 offen offset:1024 nt lds
  s_add_u32 s59, s59, 10240
  s_and_b32 s59, s59, 65535
  s_add_u32 s60, s60, 65536
  s_and_b32 s60, s60, 0x1fffff
  s_add_u32 s44, s59, s60
  s_waitcnt vmcnt(16)
  ds_read_b128 v[64:67], v6 offset:8192
  ds_read_b128 v[68:71], v7 offset:8192
  ds_read_b128 v[72:75], v8 offset:8192
  ds_read_b128 v[76:79], v9 offset:8192
  s_waitcnt lgkmcnt(3)
  v_mfma_f32_16x16x32_bf16 v[80:83], v[64:67], v[16:19], 0
  ds_read_b128 v[64:67], v6 offset:12288
  s_waitcnt lgkmcnt(3)
  v_mfma_f32_16x16x32_bf16 v[80:83], v[68:71], v[20:23], v[80:83]
  ds_read_b128 v[68:71], v7 offset:12288
  s_waitcnt lgkmcnt(3)
  v_mfma_f32_16x16x32_bf16 v[80:83], v[72:75], v[24:27], v[80:83]
  ds_read_b128 v[72:75], v8 offset:12288
  s_waitcnt lgkmcnt(3)
  v_mfma_f32_16x16x32_bf16 v[80:83], v[76:79], v[28:31], v[80:83]
  ds_read_b128 v[76:79], v9 offset:12288
  s_waitcnt lgkmcnt(3)
  v_mfma_f32_16x16x32_bf16 v[84:87], v[64:67], v[16:19], 0
  s_waitcnt lgkmcnt(2)
  v_mfma_f32_16x16x32_bf16 v[84:87], v[68:71], v[20:23], v[84:87]
  s_waitcnt lgkmcnt(1)
  v_mfma_f32_16x16x32_bf16 v[84:87], v[72:75], v[24:27], v[84:87]
  s_waitcnt lgkmcnt(0)
  v_mfma_f32_16x16x32_bf16 v[84:87], v[76:79], v[28:31], v[84:87]
  v_cvt_pk_bf16_f32 v92, v80, v81
  v_cvt_pk_bf16_f32 v93, v82, v83
  s_nop 5
  v_cvt_pk_bf16_f32 v94, v84, v85
  v_cvt_pk_bf16_f32 v95, v86, v87
  v_lshlrev_b32 v80, 16, v92
  v_and_b32 v81, 0xffff0000, v92
  v_lshlrev_b32 v82, 16, v93
  v_and_b32 v83, 0xffff0000, v93
  v_lshlrev_b32 v84, 16, v94
  v_and_b32 v85, 0xffff0000, v94
  v_lshlrev_b32 v86, 16, v95
  v_and_b32 v87, 0xffff0000, v95
  v_pk_mul_f32 v[80:81], v[80:81], s[50:51] op_sel_hi:[1,0]
  v_pk_mul_f32 v[82:83], v[82:83], s[50:51] op_sel_hi:[1,0]
  v_pk_mul_f32 v[84:85], v[84:85], s[50:51] op_sel_hi:[1,0]
  v_pk_mul_f32 v[86:87], v[86:87], s[50:51] op_sel_hi:[1,0]
  v_cvt_pk_bf16_f32 v92, v80, v81
  v_cvt_pk_bf16_f32 v93, v82, v83
  v_cvt_pk_bf16_f32 v94, v84, v85
  v_cvt_pk_bf16_f32 v95, v86, v87
  v_lshlrev_b32 v80, 16, v92
  v_and_b32 v81, 0xffff0000, v92
  v_lshlrev_b32 v82, 16, v93
  v_and_b32 v83, 0xffff0000, v93
  v_lshlrev_b32 v84, 16, v94
  v_and_b32 v85, 0xffff0000, v94
  v_lshlrev_b32 v86, 16, v95
  v_and_b32 v87, 0xffff0000, v95
  v_max3_f32 v13, v80, v81, v82
  v_max3_f32 v14, v83, v84, v85
  v_max3_f32 v13, v13, v86, v87
  v_max_f32 v13, v13, v14
  v_mov_b32 v14, v13
  s_nop 1
  v_permlane32_swap_b32 v13, v14
  v_max_f32 v13, v13, v14
  v_mov_b32 v14, v13
  s_nop 1
  v_permlane16_swap_b32 v13, v14
  v_max_f32 v13, v13, v14
  v_mul_f32 v13, s52, v13
  v_max_f32 v13, v13, v10
  v_sub_f32 v12, v10, v13
  v_mov_b32 v10, v13
  v_exp_f32 v12, v12
  v_pk_fma_f32 v[80:81], v[80:81], s[52:53], v[10:11] op_sel_hi:[1,0,0] neg_lo:[0,0,1] neg_hi:[0,0,1]
  v_pk_fma_f32 v[82:83], v[82:83], s[52:53], v[10:11] op_sel_hi:[1,0,0] neg_lo:[0,0,1] neg_hi:[0,0,1]
  v_pk_fma_f32 v[84:85], v[84:85], s[52:53], v[10:11] op_sel_hi:[1,0,0] neg_lo:[0,0,1] neg_hi:[0,0,1]
  v_pk_fma_f32 v[86:87], v[86:87], s[52:53], v[10:11] op_sel_hi:[1,0,0] neg_lo:[0,0,1] neg_hi:[0,0,1]
  v_exp_f32 v80, v80
  v_exp_f32 v81, v81
  v_exp_f32 v82, v82
  v_exp_f32 v83, v83
  v_exp_f32 v84, v84
  v_exp_f32 v85, v85
  v_exp_f32 v86, v86
  v_exp_f32 v87, v87
  v_pk_mul_f32 v[32:33], v[32:33], v[12:13] op_sel_hi:[1,0]
  v_pk_mul_f32 v[34:35], v[34:35], v[12:13] op_sel_hi:[1,0]
  v_pk_mul_f32 v[36:37], v[36:37], v[12:13] op_sel_hi:[1,0]
  v_pk_mul_f32 v[38:39], v[38:39], v[12:13] op_sel_hi:[1,0]
  v_pk_mul_f32 v[40:41], v[40:41], v[12:13] op_sel_hi:[1,0]
  v_pk_mul_f32 v[42:43], v[42:43], v[12:13] op_sel_hi:[1,0]
  v_pk_mul_f32 v[44:45], v[44:45], v[12:13] op_sel_hi:[1,0]
  v_pk_mul_f32 v[46:47], v[46:47], v[12:13] op_sel_hi:[1,0]
  v_pk_mul_f32 v[48:49], v[48:49], v[12:13] op_sel_hi:[1,0]
  v_pk_mul_f32 v[50:51], v[50:51], v[12:13] op_sel_hi:[1,0]
  v_pk_mul_f32 v[52:53], v[52:53], v[12:13] op_sel_hi:[1,0]
  v_pk_mul_f32 v[54:55], v[54:55], v[12:13] op_sel_hi:[1,0]
  v_pk_mul_f32 v[56:57], v[56:57], v[12:13] op_sel_hi:[1,0]
  v_pk_mul_f32 v[58:59], v[58:59], v[12:13] op_sel_hi:[1,0]
  v_pk_mul_f32 v[60:61], v[60:61], v[12:13] op_sel_hi:[1,0]
  v_pk_mul_f32 v[62:63], v[62:63], v[12:13] op_sel_hi:[1,0]
L_nors_6:
  v_cvt_pk_bf16_f32 v88, v80, v81
  v_cvt_pk_bf16_f32 v89, v82, v83
  v_cvt_pk_bf16_f32 v90, v84, v85
  v_cvt_pk_bf16_f32 v91, v86, v87
  v_lshlrev_b32 v80, 16, v88
  v_and_b32 v81, 0xffff0000, v88
  v_lshlrev_b32 v82, 16, v89
  v_and_b32 v83, 0xffff0000, v89
  v_lshlrev_b32 v84, 16, v90
  v_and_b32 v85, 0xffff0000, v90
  v_lshlrev_b32 v86, 16, v91
  v_and_b32 v87, 0xffff0000, v91
  v_pk_add_f32 v[80:81], v[80:81], v[82:83]
  v_pk_add_f32 v[84:85], v[84:85], v[86:87]
  v_pk_add_f32 v[80:81], v[80:81], v[84:85]
  v_add_f32 v80, v80, v81
  v_fma_f32 v11, v11, v12, v80
  s_waitcnt vmcnt(24)
  v_perm_b32 v64, v100, v96, s47
  v_perm_b32 v65, v108, v104, s47
  v_perm_b32 v66, v116, v112, s47
  v_perm_b32 v67, v124, v120, s47
  v_perm_b32 v68, v100, v96, s48
  v_perm_b32 v69, v108, v104, s48
  v_perm_b32 v70, v116, v112, s48
  v_perm_b32 v71, v124, v120, s48
  v_mfma_f32_16x16x32_bf16 v[32:35], v[64:67], v[88:91], v[32:35]
  v_perm_b32 v72, v101, v97, s47
  v_perm_b32 v73, v109, v105, s47
  v_perm_b32 v74, v117, v113, s47
  v_perm_b32 v75, v125, v121, s47
  v_mfma_f32_16x16x32_bf16 v[36:39], v[68:71], v[88:91], v[36:39]
  v_perm_b32 v76, v101, v97, s48
  v_perm_b32 v77, v109, v105, s48
  v_perm_b32 v78, v117, v113, s48
  v_perm_b32 v79, v125, v121, s48
  v_mfma_f32_16x16x32_bf16 v[40:43], v[72:75], v[88:91], v[40:43]
  v_perm_b32 v64, v102, v98, s47
  v_perm_b32 v65, v110, v106, s47
  v_perm_b32 v66, v118, v114, s47
  v_perm_b32 v67, v126, v122, s47
  v_mfma_f32_16x16x32_bf16 v[44:47], v[76:79], v[88:91], v[44:47]
  v_perm_b32 v68, v102, v98, s48
  v_perm_b32 v69, v110, v106, s48
  v_perm_b32 v70, v118, v114, s48
  v_perm_b32 v71, v126, v122, s48
  v_mfma_f32_16x16x32_bf16 v[48:51], v[64:67], v[88:91], v[48:51]
  v_perm_b32 v72, v103, v99, s47
  v_perm_b32 v73, v111, v107, s47
  v_perm_b32 v74, v119, v115, s47
  v_perm_b32 v75, v127, v123, s47
  v_mfma_f32_16x16x32_bf16 v[52:55], v[68:71], v[88:91], v[52:55]
  v_perm_b32 v76, v103, v99, s48
  v_perm_b32 v77, v111, v107, s48
  v_perm_b32 v78, v119, v115, s48
  v_perm_b32 v79, v127, v123, s48
  v_mfma_f32_16x16x32_bf16 v[56:59], v[72:75], v[88:91], v[56:59]
  s_nop 0
  v_mfma_f32_16x16x32_bf16 v[60:63], v[76:79], v[88:91], v[60:63]
  s_add_u32 m0, s46, 24576
  s_waitcnt vmcnt(11)
  buffer_load_dwordx4 v2, s[36:39], s44 offen offset:0 nt lds
  s_waitcnt vmcnt(11)
  buffer_load_dwordx4 v3, s[36:39], s44 offen offset:1024 nt lds
  s_add_u32 s59, s59, 10240
  s_and_b32 s59, s59, 65535
  s_add_u32 s60, s60, 65536
  s_and_b32 s60, s60, 0x1fffff
  s_add_u32 s44, s59, s60
  s_add_u32 m0, s46, 26624
  s_waitcnt vmcnt(11)
  buffer_load_dwordx4 v4, s[36:39], s44 offen offset:0 nt lds
  s_waitcnt vmcnt(11)
  buffer_load_dwordx4 v5, s[36:39], s44 offen offset:1024 nt lds
  s_add_u32 s59, s59, 10240
  s_and_b32 s59, s59, 65535
  s_add_u32 s60, s60, 65536
  s_and_b32 s60, s60, 0x1fffff
  s_add_u32 s44, s59, s60
  s_add_u32 m0, s46, 28672
  s_waitcnt vmcnt(11)
  buffer_load_dwordx4 v2, s[36:39], s44 offen offset:0 nt lds
  s_waitcnt vmcnt(11)
  buffer_load_dwordx4 v3, s[36:39], s44 offen offset:1024 nt lds
  s_add_u32 s59, s59, 10240
  s_and_b32 s59, s59, 65535
  s_add_u32 s60, s60, 65536
  s_and_b32 s60, s60, 0x1fffff
  s_add_u32 s44, s59, s60
  s_add_u32 m0, s46, 30720
  s_waitcnt vmcnt(11)
  buffer_load_dwordx4 v4, s[36:39], s44 offen offset:0 nt lds
  s_waitcnt vmcnt(11)
  buffer_load_dwordx4 v5, s[36:39], s44 offen offset:1024 nt lds
  s_add_u32 s59, s59, 10240
  s_and_b32 s59, s59, 65535
  s_add_u32 s60, s60, 65536
  s_and_b32 s60, s60, 0x1fffff
  s_add_u32 s44, s59, s60
  s_waitcnt vmcnt(8)
  ds_read_b128 v[64:67], v6 offset:16384
  ds_read_b128 v[68:71], v7 offset:16384
  ds_read_b128 v[72:75], v8 offset:16384
  ds_read_b128 v[76:79], v9 offset:16384
  s_waitcnt lgkmcnt(3)
  v_mfma_f32_16x16x32_bf16 v[80:83], v[64:67], v[16:19], 0
  ds_read_b128 v[64:67], v6 offset:20480
  s_waitcnt lgkmcnt(3)
  v_mfma_f32_16x16x32_bf16 v[80:83], v[68:71], v[20:23], v[80:83]
  ds_read_b128 v[68:71], v7 offset:20480
  s_waitcnt lgkmcnt(3)
  v_mfma_f32_16x16x32_bf16 v[80:83], v[72:75], v[24:27], v[80:83]
  ds_read_b128 v[72:75], v8 offset:20480
  s_waitcnt lgkmcnt(3)
  v_mfma_f32_16x16x32_bf16 v[80:83], v[76:79], v[28:31], v[80:83]
  ds_read_b128 v[76:79], v9 offset:20480
  s_waitcnt lgkmcnt(3)
  v_mfma_f32_16x16x32_bf16 v[84:87], v[64:67], v[16:19], 0
  s_waitcnt lgkmcnt(2)
  v_mfma_f32_16x16x32_bf16 v[84:87], v[68:71], v[20:23], v[84:87]
  s_waitcnt lgkmcnt(1)
  v_mfma_f32_16x16x32_bf16 v[84:87], v[72:75], v[24:27], v[84:87]
  s_waitcnt lgkmcnt(0)
  v_mfma_f32_16x16x32_bf16 v[84:87], v[76:79], v[28:31], v[84:87]
  v_cvt_pk_bf16_f32 v92, v80, v81
  v_cvt_pk_bf16_f32 v93, v82, v83
  s_nop 5
  v_cvt_pk_bf16_f32 v94, v84, v85
  v_cvt_pk_bf16_f32 v95, v86, v87
  v_lshlrev_b32 v80, 16, v92
  v_and_b32 v81, 0xffff0000, v92
  v_lshlrev_b32 v82, 16, v93
  v_and_b32 v83, 0xffff0000, v93
  v_lshlrev_b32 v84, 16, v94
  v_and_b32 v85, 0xffff0000, v94
  v_lshlrev_b32 v86, 16, v95
  v_and_b32 v87, 0xffff0000, v95
  v_pk_mul_f32 v[80:81], v[80:81], s[50:51] op_sel_hi:[1,0]
  v_pk_mul_f32 v[82:83], v[82:83], s[50:51] op_sel_hi:[1,0]
  v_pk_mul_f32 v[84:85], v[84:85], s[50:51] op_sel_hi:[1,0]
  v_pk_mul_f32 v[86:87], v[86:87], s[50:51] op_sel_hi:[1,0]
  v_cvt_pk_bf16_f32 v92, v80, v81
  v_cvt_pk_bf16_f32 v93, v82, v83
  v_cvt_pk_bf16_f32 v94, v84, v85
  v_cvt_pk_bf16_f32 v95, v86, v87
  v_lshlrev_b32 v80, 16, v92
  v_and_b32 v81, 0xffff0000, v92
  v_lshlrev_b32 v82, 16, v93
  v_and_b32 v83, 0xffff0000, v93
  v_lshlrev_b32 v84, 16, v94
  v_and_b32 v85, 0xffff0000, v94
  v_lshlrev_b32 v86, 16, v95
  v_and_b32 v87, 0xffff0000, v95
  v_max3_f32 v13, v80, v81, v82
  v_max3_f32 v14, v83, v84, v85
  v_max3_f32 v13, v13, v86, v87
  v_max_f32 v13, v13, v14
  v_mov_b32 v14, v13
  s_nop 1
  v_permlane32_swap_b32 v13, v14
  v_max_f32 v13, v13, v14
  v_mov_b32 v14, v13
  s_nop 1
  v_permlane16_swap_b32 v13, v14
  v_max_f32 v13, v13, v14
  v_mul_f32 v13, s52, v13
  v_max_f32 v13, v13, v10
  v_sub_f32 v12, v10, v13
  v_mov_b32 v10, v13
  v_exp_f32 v12, v12
  v_pk_fma_f32 v[80:81], v[80:81], s[52:53], v[10:11] op_sel_hi:[1,0,0] neg_lo:[0,0,1] neg_hi:[0,0,1]
  v_pk_fma_f32 v[82:83], v[82:83], s[52:53], v[10:11] op_sel_hi:[1,0,0] neg_lo:[0,0,1] neg_hi:[0,0,1]
  v_pk_fma_f32 v[84:85], v[84:85], s[52:53], v[10:11] op_sel_hi:[1,0,0] neg_lo:[0,0,1] neg_hi:[0,0,1]
  v_pk_fma_f32 v[86:87], v[86:87], s[52:53], v[10:11] op_sel_hi:[1,0,0] neg_lo:[0,0,1] neg_hi:[0,0,1]
  v_exp_f32 v80, v80
  v_exp_f32 v81, v81
  v_exp_f32 v82, v82
  v_exp_f32 v83, v83
  v_exp_f32 v84, v84
  v_exp_f32 v85, v85
  v_exp_f32 v86, v86
  v_exp_f32 v87, v87
  v_pk_mul_f32 v[32:33], v[32:33], v[12:13] op_sel_hi:[1,0]
  v_pk_mul_f32 v[34:35], v[34:35], v[12:13] op_sel_hi:[1,0]
  v_pk_mul_f32 v[36:37], v[36:37], v[12:13] op_sel_hi:[1,0]
  v_pk_mul_f32 v[38:39], v[38:39], v[12:13] op_sel_hi:[1,0]
  v_pk_mul_f32 v[40:41], v[40:41], v[12:13] op_sel_hi:[1,0]
  v_pk_mul_f32 v[42:43], v[42:43], v[12:13] op_sel_hi:[1,0]
  v_pk_mul_f32 v[44:45], v[44:45], v[12:13] op_sel_hi:[1,0]
  v_pk_mul_f32 v[46:47], v[46:47], v[12:13] op_sel_hi:[1,0]
  v_pk_mul_f32 v[48:49], v[48:49], v[12:13] op_sel_hi:[1,0]
  v_pk_mul_f32 v[50:51], v[50:51], v[12:13] op_sel_hi:[1,0]
  v_pk_mul_f32 v[52:53], v[52:53], v[12:13] op_sel_hi:[1,0]
  v_pk_mul_f32 v[54:55], v[54:55], v[12:13] op_sel_hi:[1,0]
  v_pk_mul_f32 v[56:57], v[56:57], v[12:13] op_sel_hi:[1,0]
  v_pk_mul_f32 v[58:59], v[58:59], v[12:13] op_sel_hi:[1,0]
  v_pk_mul_f32 v[60:61], v[60:61], v[12:13] op_sel_hi:[1,0]
  v_pk_mul_f32 v[62:63], v[62:63], v[12:13] op_sel_hi:[1,0]
L_nors_7:
  v_cvt_pk_bf16_f32 v88, v80, v81
  v_cvt_pk_bf16_f32 v89, v82, v83
  v_cvt_pk_bf16_f32 v90, v84, v85
  v_cvt_pk_bf16_f32 v91, v86, v87
  v_lshlrev_b32 v80, 16, v88
  v_and_b32 v81, 0xffff0000, v88
  v_lshlrev_b32 v82, 16, v89
  v_and_b32 v83, 0xffff0000, v89
  v_lshlrev_b32 v84, 16, v90
  v_and_b32 v85, 0xffff0000, v90
  v_lshlrev_b32 v86, 16, v91
  v_and_b32 v87, 0xffff0000, v91
  v_pk_add_f32 v[80:81], v[80:81], v[82:83]
  v_pk_add_f32 v[84:85], v[84:85], v[86:87]
  v_pk_add_f32 v[80:81], v[80:81], v[84:85]
  v_add_f32 v80, v80, v81
  v_fma_f32 v11, v11, v12, v80
  s_waitcnt vmcnt(16)
  v_perm_b32 v64, v132, v128, s47
  v_perm_b32 v65, v140, v136, s47
  v_perm_b32 v66, v148, v144, s47
  v_perm_b32 v67, v156, v152, s47
  v_perm_b32 v68, v132, v128, s48
  v_perm_b32 v69, v140, v136, s48
  v_perm_b32 v70, v148, v144, s48
  v_perm_b32 v71, v156, v152, s48
  v_mfma_f32_16x16x32_bf16 v[32:35], v[64:67], v[88:91], v[32:35]
  v_perm_b32 v72, v133, v129, s47
  v_perm_b32 v73, v141, v137, s47
  v_perm_b32 v74, v149, v145, s47
  v_perm_b32 v75, v157, v153, s47
  v_mfma_f32_16x16x32_bf16 v[36:39], v[68:71], v[88:91], v[36:39]
  v_perm_b32 v76, v133, v129, s48
  v_perm_b32 v77, v141, v137, s48
  v_perm_b32 v78, v149, v145, s48
  v_perm_b32 v79, v157, v153, s48
  v_mfma_f32_16x16x32_bf16 v[40:43], v[72:75], v[88:91], v[40:43]
  v_perm_b32 v64, v134, v130, s47
  v_perm_b32 v65, v142, v138, s47
  v_perm_b32 v66, v150, v146, s47
  v_perm_b32 v67, v158, v154, s47
  v_mfma_f32_16x16x32_bf16 v[44:47], v[76:79], v[88:91], v[44:47]
  v_perm_b32 v68, v134, v130, s48
  v_perm_b32 v69, v142, v138, s48
  v_perm_b32 v70, v150, v146, s48
  v_perm_b32 v71, v158, v154, s48
  v_mfma_f32_16x16x32_bf16 v[48:51], v[64:67], v[88:91], v[48:51]
  v_perm_b32 v72, v135, v131, s47
  v_perm_b32 v73, v143, v139, s47
  v_perm_b32 v74, v151, v147, s47
  v_perm_b32 v75, v159, v155, s47
  v_mfma_f32_16x16x32_bf16 v[52:55], v[68:71], v[88:91], v[52:55]
  v_perm_b32 v76, v135, v131, s48
  v_perm_b32 v77, v143, v139, s48
  v_perm_b32 v78, v151, v147, s48
  v_perm_b32 v79, v159, v155, s48
  v_mfma_f32_16x16x32_bf16 v[56:59], v[72:75], v[88:91], v[56:59]
  s_nop 0
  v_mfma_f32_16x16x32_bf16 v[60:63], v[76:79], v[88:91], v[60:63]
  s_waitcnt vmcnt(11)
  buffer_load_dwordx4 v[160:163], v1, s[40:43], s45 offen offset:0 nt
  s_waitcnt vmcnt(11)
  buffer_load_dwordx4 v[164:167], v1, s[40:43], s45 offen offset:1024 nt
  s_add_u32 s61, s61, 10240
  s_and_b32 s61, s61, 65535
  s_add_u32 s62, s62, 65536
  s_and_b32 s62, s62, 0x1fffff
  s_add_u32 s45, s61, s62
  s_waitcnt vmcnt(11)
  buffer_load_dwordx4 v[168:171], v1, s[40:43], s45 offen offset:0 nt
  s_waitcnt vmcnt(11)
  buffer_load_dwordx4 v[172:175], v1, s[40:43], s45 offen offset:1024 nt
  s_add_u32 s61, s61, 10240
  s_and_b32 s61, s61, 65535
  s_add_u32 s62, s62, 65536
  s_and_b32 s62, s62, 0x1fffff
  s_add_u32 s45, s61, s62
  s_waitcnt vmcnt(11)
  buffer_load_dwordx4 v[176:179], v1, s[40:43], s45 offen offset:0 nt
  s_waitcnt vmcnt(11)
  buffer_load_dwordx4 v[180:183], v1, s[40:43], s45 offen offset:1024 nt
  s_add_u32 s61, s61, 10240
  s_and_b32 s61, s61, 65535
  s_add_u32 s62, s62, 65536
  s_and_b32 s62, s62, 0x1fffff
  s_add_u32 s45, s61, s62
  s_waitcnt vmcnt(11)
  buffer_load_dwordx4 v[184:187], v1, s[40:43], s45 offen offset:0 nt
  s_waitcnt vmcnt(11)
  buffer_load_dwordx4 v[188:191], v1, s[40:43], s45 offen offset:1024 nt
  s_add_u32 s61, s61, 10240
  s_and_b32 s61, s61, 65535
  s_add_u32 s62, s62, 65536
  s_and_b32 s62, s62, 0x1fffff
  s_add_u32 s45, s61, s62
  v_mov_b32 v13, 157896
  v_mov_b32 v14, 1
  s_mov_b64 exec, 1
  ds_add_u32 v13, v14
  s_mov_b64 exec, -1
  s_waitcnt vmcnt(8)
  ds_read_b128 v[64:67], v6 offset:24576
  ds_read_b128 v[68:71], v7 offset:24576
  ds_read_b128 v[72:75], v8 offset:24576
  ds_read_b128 v[76:79], v9 offset:24576
  s_waitcnt lgkmcnt(3)
  v_mfma_f32_16x16x32_bf16 v[80:83], v[64:67], v[16:19], 0
  ds_read_b128 v[64:67], v6 offset:28672
  s_waitcnt lgkmcnt(3)
  v_mfma_f32_16x16x32_bf16 v[80:83], v[68:71], v[20:23], v[80:83]
  ds_read_b128 v[68:71], v7 offset:28672
  s_waitcnt lgkmcnt(3)
  v_mfma_f32_16x16x32_bf16 v[80:83], v[72:75], v[24:27], v[80:83]
  ds_read_b128 v[72:75], v8 offset:28672
  s_waitcnt lgkmcnt(3)
  v_mfma_f32_16x16x32_bf16 v[80:83], v[76:79], v[28:31], v[80:83]
  ds_read_b128 v[76:79], v9 offset:28672
  s_waitcnt lgkmcnt(3)
  v_mfma_f32_16x16x32_bf16 v[84:87], v[64:67], v[16:19], 0
  s_waitcnt lgkmcnt(2)
  v_mfma_f32_16x16x32_bf16 v[84:87], v[68:71], v[20:23], v[84:87]
  s_waitcnt lgkmcnt(1)
  v_mfma_f32_16x16x32_bf16 v[84:87], v[72:75], v[24:27], v[84:87]
  s_waitcnt lgkmcnt(0)
  v_mfma_f32_16x16x32_bf16 v[84:87], v[76:79], v[28:31], v[84:87]
  v_cvt_pk_bf16_f32 v92, v80, v81
  v_cvt_pk_bf16_f32 v93, v82, v83
  s_nop 5
  v_cvt_pk_bf16_f32 v94, v84, v85
  v_cvt_pk_bf16_f32 v95, v86, v87
  v_lshlrev_b32 v80, 16, v92
  v_and_b32 v81, 0xffff0000, v92
  v_lshlrev_b32 v82, 16, v93
  v_and_b32 v83, 0xffff0000, v93
  v_lshlrev_b32 v84, 16, v94
  v_and_b32 v85, 0xffff0000, v94
  v_lshlrev_b32 v86, 16, v95
  v_and_b32 v87, 0xffff0000, v95
  v_pk_mul_f32 v[80:81], v[80:81], s[50:51] op_sel_hi:[1,0]
  v_pk_mul_f32 v[82:83], v[82:83], s[50:51] op_sel_hi:[1,0]
  v_pk_mul_f32 v[84:85], v[84:85], s[50:51] op_sel_hi:[1,0]
  v_pk_mul_f32 v[86:87], v[86:87], s[50:51] op_sel_hi:[1,0]
  v_cvt_pk_bf16_f32 v92, v80, v81
  v_cvt_pk_bf16_f32 v93, v82, v83
  v_cvt_pk_bf16_f32 v94, v84, v85
  v_cvt_pk_bf16_f32 v95, v86, v87
  v_lshlrev_b32 v80, 16, v92
  v_and_b32 v81, 0xffff0000, v92
  v_lshlrev_b32 v82, 16, v93
  v_and_b32 v83, 0xffff0000, v93
  v_lshlrev_b32 v84, 16, v94
  v_and_b32 v85, 0xffff0000, v94
  v_lshlrev_b32 v86, 16, v95
  v_and_b32 v87, 0xffff0000, v95
  v_max3_f32 v13, v80, v81, v82
  v_max3_f32 v14, v83, v84, v85
  v_max3_f32 v13, v13, v86, v87
  v_max_f32 v13, v13, v14
  v_mov_b32 v14, v13
  s_nop 1
  v_permlane32_swap_b32 v13, v14
  v_max_f32 v13, v13, v14
  v_mov_b32 v14, v13
  s_nop 1
  v_permlane16_swap_b32 v13, v14
  v_max_f32 v13, v13, v14
  v_mul_f32 v13, s52, v13
  v_max_f32 v13, v13, v10
  v_sub_f32 v12, v10, v13
  v_mov_b32 v10, v13
  v_exp_f32 v12, v12
  v_pk_fma_f32 v[80:81], v[80:81], s[52:53], v[10:11] op_sel_hi:[1,0,0] neg_lo:[0,0,1] neg_hi:[0,0,1]
  v_pk_fma_f32 v[82:83], v[82:83], s[52:53], v[10:11] op_sel_hi:[1,0,0] neg_lo:[0,0,1] neg_hi:[0,0,1]
  v_pk_fma_f32 v[84:85], v[84:85], s[52:53], v[10:11] op_sel_hi:[1,0,0] neg_lo:[0,0,1] neg_hi:[0,0,1]
  v_pk_fma_f32 v[86:87], v[86:87], s[52:53], v[10:11] op_sel_hi:[1,0,0] neg_lo:[0,0,1] neg_hi:[0,0,1]
  v_exp_f32 v80, v80
  v_exp_f32 v81, v81
  v_exp_f32 v82, v82
  v_exp_f32 v83, v83
  v_exp_f32 v84, v84
  v_exp_f32 v85, v85
  v_exp_f32 v86, v86
  v_exp_f32 v87, v87
  v_pk_mul_f32 v[32:33], v[32:33], v[12:13] op_sel_hi:[1,0]
  v_pk_mul_f32 v[34:35], v[34:35], v[12:13] op_sel_hi:[1,0]
  v_pk_mul_f32 v[36:37], v[36:37], v[12:13] op_sel_hi:[1,0]
  v_pk_mul_f32 v[38:39], v[38:39], v[12:13] op_sel_hi:[1,0]
  v_pk_mul_f32 v[40:41], v[40:41], v[12:13] op_sel_hi:[1,0]
  v_pk_mul_f32 v[42:43], v[42:43], v[12:13] op_sel_hi:[1,0]
  v_pk_mul_f32 v[44:45], v[44:45], v[12:13] op_sel_hi:[1,0]
  v_pk_mul_f32 v[46:47], v[46:47], v[12:13] op_sel_hi:[1,0]
  v_pk_mul_f32 v[48:49], v[48:49], v[12:13] op_sel_hi:[1,0]
  v_pk_mul_f32 v[50:51], v[50:51], v[12:13] op_sel_hi:[1,0]
  v_pk_mul_f32 v[52:53], v[52:53], v[12:13] op_sel_hi:[1,0]
  v_pk_mul_f32 v[54:55], v[54:55], v[12:13] op_sel_hi:[1,0]
  v_pk_mul_f32 v[56:57], v[56:57], v[12:13] op_sel_hi:[1,0]
  v_pk_mul_f32 v[58:59], v[58:59], v[12:13] op_sel_hi:[1,0]
  v_pk_mul_f32 v[60:61], v[60:61], v[12:13] op_sel_hi:[1,0]
  v_pk_mul_f32 v[62:63], v[62:63], v[12:13] op_sel_hi:[1,0]
L_nors_8:
  v_cvt_pk_bf16_f32 v88, v80, v81
  v_cvt_pk_bf16_f32 v89, v82, v83
  v_cvt_pk_bf16_f32 v90, v84, v85
  v_cvt_pk_bf16_f32 v91, v86, v87
  v_lshlrev_b32 v80, 16, v88
  v_and_b32 v81, 0xffff0000, v88
  v_lshlrev_b32 v82, 16, v89
  v_and_b32 v83, 0xffff0000, v89
  v_lshlrev_b32 v84, 16, v90
  v_and_b32 v85, 0xffff0000, v90
  v_lshlrev_b32 v86, 16, v91
  v_and_b32 v87, 0xffff0000, v91
  v_pk_add_f32 v[80:81], v[80:81], v[82:83]
  v_pk_add_f32 v[84:85], v[84:85], v[86:87]
  v_pk_add_f32 v[80:81], v[80:81], v[84:85]
  v_add_f32 v80, v80, v81
  v_fma_f32 v11, v11, v12, v80
  v_mov_b32 v14, v11
  s_nop 1
  v_permlane32_swap_b32 v11, v14
  v_add_f32 v11, v11, v14
  v_mov_b32 v14, v11
  s_nop 1
  v_permlane16_swap_b32 v11, v14
  v_add_f32 v11, v11, v14
  v_and_b32 v192, 3, v0
  v_lshlrev_b32 v192, 4, v192
  v_lshrrev_b32 v14, 4, v0
  v_lshl_add_u32 v192, v14, 2, v192
  s_mul_i32 s54, s3, 2560
  s_add_u32 s54, s54, 132096
  v_add_u32 v192, s54, v192
  v_add_u32 v193, 960, v192
  v_add_u32 v194, 1920, v192
  s_lshl_b32 s54, s3, 5
  s_add_u32 s54, s54, 142336
  v_lshl_add_u32 v92, v0, 3, s54
  s_mov_b64 exec, 0xf
  ds_write_b64 v92, v[10:11]
  s_mov_b64 exec, -1
  v_mov_b32 v13, 157892
  v_mov_b32 v14, 1
  s_waitcnt lgkmcnt(0)
  s_mov_b64 exec, 1
  ds_add_u32 v13, v14
  s_mov_b64 exec, -1
  s_waitcnt vmcnt(0)
  v_perm_b32 v64, v164, v160, s47
  v_perm_b32 v65, v172, v168, s47
  v_perm_b32 v66, v180, v176, s47
  v_perm_b32 v67, v188, v184, s47
  v_perm_b32 v68, v164, v160, s48
  v_perm_b32 v69, v172, v168, s48
  v_perm_b32 v70, v180, v176, s48
  v_perm_b32 v71, v188, v184, s48
  v_mfma_f32_16x16x32_bf16 v[32:35], v[64:67], v[88:91], v[32:35]
  v_perm_b32 v72, v165, v161, s47
  v_perm_b32 v73, v173, v169, s47
  v_perm_b32 v74, v181, v177, s47
  v_perm_b32 v75, v189, v185, s47
  v_mfma_f32_16x16x32_bf16 v[36:39], v[68:71], v[88:91], v[36:39]
  v_perm_b32 v76, v165, v161, s48
  v_perm_b32 v77, v173, v169, s48
  v_perm_b32 v78, v181, v177, s48
  v_perm_b32 v79, v189, v185, s48
  v_mfma_f32_16x16x32_bf16 v[40:43], v[72:75], v[88:91], v[40:43]
  v_perm_b32 v64, v166, v162, s47
  v_perm_b32 v65, v174, v170, s47
  v_perm_b32 v66, v182, v178, s47
  v_perm_b32 v67, v190, v186, s47
  v_mfma_f32_16x16x32_bf16 v[44:47], v[76:79], v[88:91], v[44:47]
  v_perm_b32 v68, v166, v162, s48
  v_perm_b32 v69, v174, v170, s48
  v_perm_b32 v70, v182, v178, s48
  v_perm_b32 v71, v190, v186, s48
  v_mfma_f32_16x16x32_bf16 v[48:51], v[64:67], v[88:91], v[48:51]
  s_mov_b32 exec_lo, 0x000f000f
  s_mov_b32 exec_hi, 0x000f000f
  ds_write2_b32 v192, v32, v36 offset0:0 offset1:20
  ds_write2_b32 v192, v33, v37 offset0:160 offset1:180
  ds_write2_b32 v193, v34, v38 offset0:80 offset1:100
  ds_write2_b32 v194, v35, v39 offset0:0 offset1:20
  s_mov_b64 exec, -1
  v_perm_b32 v72, v167, v163, s47
  v_perm_b32 v73, v175, v171, s47
  v_perm_b32 v74, v183, v179, s47
  v_perm_b32 v75, v191, v187, s47
  v_mfma_f32_16x16x32_bf16 v[52:55], v[68:71], v[88:91], v[52:55]
  v_perm_b32 v76, v167, v163, s48
  v_perm_b32 v77, v175, v171, s48
  v_perm_b32 v78, v183, v179, s48
  v_perm_b32 v79, v191, v187, s48
  v_mfma_f32_16x16x32_bf16 v[56:59], v[72:75], v[88:91], v[56:59]
  s_mov_b32 exec_lo, 0x000f000f
  s_mov_b32 exec_hi, 0x000f000f
  ds_write2_b32 v192, v40, v44 offset0:40 offset1:60
  ds_write2_b32 v192, v41, v45 offset0:200 offset1:220
  ds_write2_b32 v193, v42, v46 offset0:120 offset1:140
  ds_write2_b32 v194, v43, v47 offset0:40 offset1:60
  s_mov_b64 exec, -1
  v_mfma_f32_16x16x32_bf16 v[60:63], v[76:79], v[88:91], v[60:63]
  s_mov_b32 exec_lo, 0x000f000f
  s_mov_b32 exec_hi, 0x000f000f
  ds_write2_b32 v192, v48, v52 offset0:80 offset1:100
  ds_write2_b32 v193, v49, v53 offset0:0 offset1:20
  ds_write2_b32 v193, v50, v54 offset0:160 offset1:180
  ds_write2_b32 v194, v51, v55 offset0:80 offset1:100
  s_mov_b64 exec, -1
  s_mov_b32 exec_lo, 0x000f000f
  s_mov_b32 exec_hi, 0x000f000f
  ds_write2_b32 v192, v56, v60 offset0:120 offset1:140
  ds_write2_b32 v193, v57, v61 offset0:40 offset1:60
  ds_write2_b32 v193, v58, v62 offset0:200 offset1:220
  ds_write2_b32 v194, v59, v63 offset0:120 offset1:140
  s_mov_b64 exec, -1
  s_waitcnt lgkmcnt(0)
  s_barrier
  s_endpgm
L_helper:
  s_setprio 2
  s_sub_u32 s36, s3, 4
  v_lshrrev_b32 v1, 4, v0
  v_and_b32 v2, 15, v0
  s_mov_b32 s38, 0x05040100
  s_mov_b32 s39, 0x07060302
  v_mov_b32 v3, 157888
  v_mov_b32 v4, 0
  v_mov_b32 v5, 0
  v_mov_b32 v6, 0
  v_mov_b32 v7, 0
  ds_write_b128 v3, v[4:7]
  s_mov_b32 s98, 0x07060500
  s_mov_b32 s99, 0x07060501
  s_mov_b32 s100, 0x07060502
  s_mov_b32 s101, 0x07060503
  s_lshl_b32 s53, s36, 11
  s_add_u32 s53, s53, 142464
  s_waitcnt lgkmcnt(0)
  s_load_dword s37, s[30:31], 0
  s_mov_b32 s40, s30
  s_and_b32 s41, s31, 0xffff
  s_mov_b32 s42, 0x10000000
  s_mov_b32 s43, 0x20000
  s_cmp_eq_u32 s36, 1
  s_cbranch_scc1 L_B
  s_add_u32 s62, s33, 16
  s_cmp_eq_u32 s36, 2
  s_cbranch_scc1 L_Aunit
  s_mov_b32 s62, s33
  s_cmp_eq_u32 s36, 0
  s_cselect_b32 s55, s33, 99
  s_cmp_lt_u32 s55, 16
  s_cbranch_scc1 L_Aunit
  s_waitcnt lgkmcnt(0)
  s_barrier
  s_cmp_eq_u32 s36, 0
  s_cbranch_scc0 L_idle
  s_cmp_eq_u32 s35, 7
  s_cbranch_scc0 L_idle
  s_cmp_lt_u32 s54, 16
  s_cbranch_scc1 L_Ared0
  s_branch L_idle
L_Aunit:
  s_mov_b32 s44, s24
  s_and_b32 s45, s25, 0xffff
  s_mov_b32 s46, 0x00300000
  s_mov_b32 s47, 0x20000
  s_mov_b32 s48, s22
  s_and_b32 s49, s23, 0xffff
  s_mov_b32 s50, 0x00001000
  s_mov_b32 s51, 0x20000
  v_and_b32 v3, 3, v2
  v_lshrrev_b32 v4, 2, v2
  v_and_b32 v4, 1, v4
  v_lshlrev_b32 v6, 10, v3
  v_lshl_add_u32 v6, v1, 5, v6
  v_lshl_add_u32 v6, v4, 4, v6
  s_lshl_b32 s57, s32, 7
  buffer_load_dwordx4 v[16:19], v6, s[48:51], s57 offen
  v_lshrrev_b32 v7, 3, v2
  v_lshlrev_b32 v7, 3, v7
  v_lshl_add_u32 v7, v1, 4, v7
  v_mul_u32_u24 v7, 6144, v7
  v_and_b32 v8, 7, v2
  v_lshl_add_u32 v7, v8, 4, v7
  s_lshl_b32 s55, s62, 7
  s_mul_i32 s56, s32, 393216
  s_add_u32 s55, s55, s56
  s_add_u32 s56, s55, 0
  buffer_load_dwordx4 v[128:131], v7, s[44:47], s56 offen nt
  s_add_u32 s56, s55, 6144
  buffer_load_dwordx4 v[132:135], v7, s[44:47], s56 offen nt
  s_add_u32 s56, s55, 12288
  buffer_load_dwordx4 v[136:139], v7, s[44:47], s56 offen nt
  s_add_u32 s56, s55, 18432
  buffer_load_dwordx4 v[140:143], v7, s[44:47], s56 offen nt
  s_add_u32 s56, s55, 24576
  buffer_load_dwordx4 v[144:147], v7, s[44:47], s56 offen nt
  s_add_u32 s56, s55, 30720
  buffer_load_dwordx4 v[148:151], v7, s[44:47], s56 offen nt
  s_add_u32 s56, s55, 36864
  buffer_load_dwordx4 v[152:155], v7, s[44:47], s56 offen nt
  s_add_u32 s56, s55, 43008
  buffer_load_dwordx4 v[156:159], v7, s[44:47], s56 offen nt
  s_waitcnt lgkmcnt(0)
  s_barrier
  s_mov_b32 s57, 0xbfb8aa3b
  s_lshl_b32 s55, s62, 3
  s_add_u32 s55, s55, s32
  s_lshl_b32 s55, s55, 10
  s_add_u32 s60, s55, 1572864
  v_lshlrev_b32 v12, 4, v0
  s_waitcnt vmcnt(8)
  v_lshlrev_b32 v32, 16, v16
  v_and_b32 v33, 0xffff0000, v16
  v_lshlrev_b32 v34, 16, v17
  v_and_b32 v35, 0xffff0000, v17
  v_lshlrev_b32 v36, 16, v18
  v_and_b32 v37, 0xffff0000, v18
  v_lshlrev_b32 v38, 16, v19
  v_and_b32 v39, 0xffff0000, v19
  v_mul_f32 v40, s57, v32
  v_mul_f32 v41, s57, v33
  v_mul_f32 v42, s57, v34
  v_mul_f32 v43, s57, v35
  v_mul_f32 v44, s57, v36
  v_mul_f32 v45, s57, v37
  v_mul_f32 v46, s57, v38
  v_mul_f32 v47, s57, v39
  v_exp_f32 v40, v40
  v_exp_f32 v41, v41
  v_exp_f32 v42, v42
  v_exp_f32 v43, v43
  v_exp_f32 v44, v44
  v_exp_f32 v45, v45
  v_exp_f32 v46, v46
  v_exp_f32 v47, v47
  v_add_f32 v40, 1.0, v40
  v_add_f32 v41, 1.0, v41
  v_add_f32 v42, 1.0, v42
  v_add_f32 v43, 1.0, v43
  v_add_f32 v44, 1.0, v44
  v_add_f32 v45, 1.0, v45
  v_add_f32 v46, 1.0, v46
  v_add_f32 v47, 1.0, v47
  v_rcp_f32 v40, v40
  v_rcp_f32 v41, v41
  v_rcp_f32 v42, v42
  v_rcp_f32 v43, v43
  v_rcp_f32 v44, v44
  v_rcp_f32 v45, v45
  v_rcp_f32 v46, v46
  v_rcp_f32 v47, v47
  v_mul_f32 v32, v32, v40
  v_mul_f32 v33, v33, v41
  v_mul_f32 v34, v34, v42
  v_mul_f32 v35, v35, v43
  v_mul_f32 v36, v36, v44
  v_mul_f32 v37, v37, v45
  v_mul_f32 v38, v38, v46
  v_mul_f32 v39, v39, v47
  v_cvt_pk_bf16_f32 v16, v32, v33
  v_cvt_pk_bf16_f32 v17, v34, v35
  v_cvt_pk_bf16_f32 v18, v36, v37
  v_cvt_pk_bf16_f32 v19, v38, v39
  s_waitcnt lgkmcnt(0)
  s_and_b32 s94, s37, 0x7f7f7f7f
  s_add_u32 s94, s94, 0x3d275b01
  s_xor_b32 s37, s37, 0x3da75b01
  s_and_b32 s37, s37, 0x80808080
  s_xor_b32 s37, s37, s94
  s_bfe_u32 s94, s37, 0x00080000
  s_bfe_u32 s95, s37, 0x00080008
  s_bfe_u32 s96, s37, 0x00080010
  s_bfe_u32 s97, s37, 0x00080018
  v_mov_b32 v63, s37
  s_waitcnt vmcnt(0)
  v_perm_b32 v96, v132, v128, s38
  v_perm_b32 v97, v140, v136, s38
  v_perm_b32 v98, v148, v144, s38
  v_perm_b32 v99, v156, v152, s38
  v_perm_b32 v100, v132, v128, s39
  v_perm_b32 v101, v140, v136, s39
  v_perm_b32 v102, v148, v144, s39
  v_perm_b32 v103, v156, v152, s39
  v_perm_b32 v104, v133, v129, s38
  v_perm_b32 v105, v141, v137, s38
  v_perm_b32 v106, v149, v145, s38
  v_perm_b32 v107, v157, v153, s38
  v_perm_b32 v108, v133, v129, s39
  v_perm_b32 v109, v141, v137, s39
  v_perm_b32 v110, v149, v145, s39
  v_perm_b32 v111, v157, v153, s39
  v_perm_b32 v112, v134, v130, s38
  v_perm_b32 v113, v142, v138, s38
  v_perm_b32 v114, v150, v146, s38
  v_perm_b32 v115, v158, v154, s38
  v_perm_b32 v116, v134, v130, s39
  v_perm_b32 v117, v142, v138, s39
  v_perm_b32 v118, v150, v146, s39
  v_perm_b32 v119, v158, v154, s39
  v_perm_b32 v120, v135, v131, s38
  v_perm_b32 v121, v143, v139, s38
  v_perm_b32 v122, v151, v147, s38
  v_perm_b32 v123, v159, v155, s38
  v_perm_b32 v124, v135, v131, s39
  v_perm_b32 v125, v143, v139, s39
  v_perm_b32 v126, v151, v147, s39
  v_perm_b32 v127, v159, v155, s39
  v_mfma_f32_16x16x32_bf16 v[64:67], v[16:19], v[96:99], 0
  v_mfma_f32_16x16x32_bf16 v[68:71], v[16:19], v[100:103], 0
  v_mfma_f32_16x16x32_bf16 v[72:75], v[16:19], v[104:107], 0
  v_mfma_f32_16x16x32_bf16 v[76:79], v[16:19], v[108:111], 0
  v_mfma_f32_16x16x32_bf16 v[80:83], v[16:19], v[112:115], 0
  v_mfma_f32_16x16x32_bf16 v[84:87], v[16:19], v[116:119], 0
  v_mfma_f32_16x16x32_bf16 v[88:91], v[16:19], v[120:123], 0
  v_mfma_f32_16x16x32_bf16 v[92:95], v[16:19], v[124:127], 0
  v_and_b32 v4, 7, v0
  v_lshlrev_b32 v4, 7, v4
  v_lshl_add_u32 v4, v1, 10, v4
  v_add_u32 v6, s53, v4
  v_lshlrev_b32 v4, 6, v2
  v_lshl_add_u32 v4, v1, 2, v4
  v_add_u32 v4, s53, v4
  v_add_u32 v5, 1024, v4
  s_mov_b32 exec_lo, 0xff0000ff
  s_mov_b32 exec_hi, 0
  ds_write_b128 v6, v[64:67] offset:0
  ds_write_b128 v6, v[68:71] offset:16
  ds_write_b128 v6, v[72:75] offset:32
  ds_write_b128 v6, v[76:79] offset:48
  ds_write_b128 v6, v[80:83] offset:64
  ds_write_b128 v6, v[84:87] offset:80
  ds_write_b128 v6, v[88:91] offset:96
  ds_write_b128 v6, v[92:95] offset:112
  s_mov_b64 exec, -1
  s_waitcnt lgkmcnt(0)
  ds_read2_b32 v[16:17], v4 offset0:0 offset1:4
  ds_read2_b32 v[18:19], v4 offset0:8 offset1:12
  ds_read2_b32 v[20:21], v5 offset0:0 offset1:4
  ds_read2_b32 v[22:23], v5 offset0:8 offset1:12
  s_waitcnt lgkmcnt(0)
  v_pk_add_f32 v[16:17], v[16:17], v[20:21]
  v_pk_add_f32 v[18:19], v[18:19], v[22:23]
  v_perm_b32 v16, v16, v63, s98
  v_perm_b32 v17, v17, v63, s99
  v_perm_b32 v18, v18, v63, s100
  v_perm_b32 v19, v19, v63, s101
  buffer_store_dwordx4 v[16:19], v12, s[40:43], s60 offen sc1
  s_branch L_mid
L_B:
  s_mov_b32 s44, s10
  s_and_b32 s45, s11, 0xffff
  s_mov_b32 s46, 0x00400000
  s_mov_b32 s47, 0x20000
  s_mov_b32 s48, s4
  s_and_b32 s49, s5, 0xffff
  s_mov_b32 s50, 0x00001000
  s_mov_b32 s51, 0x20000
  s_and_b32 s58, s33, 3
  s_xor_b32 s59, s35, 4
  v_and_b32 v4, 3, v2
  v_lshrrev_b32 v5, 2, v2
  v_lshl_add_u32 v6, v1, 2, v5
  v_lshlrev_b32 v6, 4, v6
  v_lshl_add_u32 v6, v4, 10, v6
  buffer_load_dwordx4 v[16:19], v6, s[48:51], 0 offen offset:0
  buffer_load_dwordx4 v[20:23], v6, s[48:51], 0 offen offset:256
  buffer_load_dwordx4 v[24:27], v6, s[48:51], 0 offen offset:512
  buffer_load_dwordx4 v[28:31], v6, s[48:51], 0 offen offset:768
  v_and_b32 v7, 1, v5
  v_lshlrev_b32 v7, 3, v7
  v_lshrrev_b32 v12, 1, v5
  v_lshl_add_u32 v7, v12, 6, v7
  v_lshl_add_u32 v7, v1, 4, v7
  s_lshl_b32 s55, s58, 7
  v_add_u32 v7, s55, v7
  v_lshlrev_b32 v12, 1, v7
  v_lshl_add_u32 v12, v4, 10, v12
  buffer_load_dwordx4 v[32:35], v12, s[48:51], 0 offen
  v_lshrrev_b32 v61, 3, v2
  v_lshlrev_b32 v61, 3, v61
  v_lshl_add_u32 v61, v1, 4, v61
  v_lshlrev_b32 v61, 13, v61
  v_and_b32 v60, 7, v2
  v_lshl_add_u32 v61, v60, 4, v61
  s_lshl_b32 s55, s58, 20
  s_lshl_b32 s56, s32, 10
  s_add_u32 s55, s55, s56
  s_lshl_b32 s56, s59, 7
  s_add_u32 s55, s55, s56
  s_add_u32 s56, s55, 0
  buffer_load_dwordx4 v[64:67], v61, s[44:47], s56 offen nt
  s_add_u32 s56, s55, 8192
  buffer_load_dwordx4 v[68:71], v61, s[44:47], s56 offen nt
  s_add_u32 s56, s55, 16384
  buffer_load_dwordx4 v[72:75], v61, s[44:47], s56 offen nt
  s_add_u32 s56, s55, 24576
  buffer_load_dwordx4 v[76:79], v61, s[44:47], s56 offen nt
  s_add_u32 s56, s55, 32768
  buffer_load_dwordx4 v[80:83], v61, s[44:47], s56 offen nt
  s_add_u32 s56, s55, 40960
  buffer_load_dwordx4 v[84:87], v61, s[44:47], s56 offen nt
  s_add_u32 s56, s55, 49152
  buffer_load_dwordx4 v[88:91], v61, s[44:47], s56 offen nt
  s_add_u32 s56, s55, 57344
  buffer_load_dwordx4 v[92:95], v61, s[44:47], s56 offen nt
  s_add_u32 s56, s55, 524288
  buffer_load_dwordx4 v[96:99], v61, s[44:47], s56 offen nt
  s_add_u32 s56, s55, 532480
  buffer_load_dwordx4 v[100:103], v61, s[44:47], s56 offen nt
  s_add_u32 s56, s55, 540672
  buffer_load_dwordx4 v[104:107], v61, s[44:47], s56 offen nt
  s_add_u32 s56, s55, 548864
  buffer_load_dwordx4 v[108:111], v61, s[44:47], s56 offen nt
  s_add_u32 s56, s55, 557056
  buffer_load_dwordx4 v[112:115], v61, s[44:47], s56 offen nt
  s_add_u32 s56, s55, 565248
  buffer_load_dwordx4 v[116:119], v61, s[44:47], s56 offen nt
  s_add_u32 s56, s55, 573440
  buffer_load_dwordx4 v[120:123], v61, s[44:47], s56 offen nt
  s_add_u32 s56, s55, 581632
  buffer_load_dwordx4 v[124:127], v61, s[44:47], s56 offen nt
  s_waitcnt lgkmcnt(0)
  s_barrier
  v_lshlrev_b32 v3, 4, v0
  s_lshl_b32 s55, s58, 16
  s_lshl_b32 s56, s32, 11
  s_add_u32 s55, s55, s56
  s_lshl_b32 s56, s59, 8
  s_add_u32 s55, s55, s56
  s_add_u32 s60, s55, 65536
  v_lshrrev_b32 v13, 1, v5
  v_lshlrev_b32 v13, 10, v13
  v_lshl_add_u32 v13, v4, 7, v13
  v_lshl_add_u32 v13, v1, 5, v13
  v_and_b32 v14, 1, v5
  v_lshl_add_u32 v13, v14, 4, v13
  s_waitcnt vmcnt(17)
  v_lshlrev_b32 v128, 16, v16
  v_and_b32 v129, 0xffff0000, v16
  v_lshlrev_b32 v130, 16, v17
  v_and_b32 v131, 0xffff0000, v17
  v_lshlrev_b32 v132, 16, v18
  v_and_b32 v133, 0xffff0000, v18
  v_lshlrev_b32 v134, 16, v19
  v_and_b32 v135, 0xffff0000, v19
  v_lshlrev_b32 v136, 16, v20
  v_and_b32 v137, 0xffff0000, v20
  v_lshlrev_b32 v138, 16, v21
  v_and_b32 v139, 0xffff0000, v21
  v_lshlrev_b32 v140, 16, v22
  v_and_b32 v141, 0xffff0000, v22
  v_lshlrev_b32 v142, 16, v23
  v_and_b32 v143, 0xffff0000, v23
  v_lshlrev_b32 v144, 16, v24
  v_and_b32 v145, 0xffff0000, v24
  v_lshlrev_b32 v146, 16, v25
  v_and_b32 v147, 0xffff0000, v25
  v_lshlrev_b32 v148, 16, v26
  v_and_b32 v149, 0xffff0000, v26
  v_lshlrev_b32 v150, 16, v27
  v_and_b32 v151, 0xffff0000, v27
  v_lshlrev_b32 v152, 16, v28
  v_and_b32 v153, 0xffff0000, v28
  v_lshlrev_b32 v154, 16, v29
  v_and_b32 v155, 0xffff0000, v29
  v_lshlrev_b32 v156, 16, v30
  v_and_b32 v157, 0xffff0000, v30
  v_lshlrev_b32 v158, 16, v31
  v_and_b32 v159, 0xffff0000, v31
  v_pk_add_f32 v[14:15], v[128:129], v[130:131]
  v_pk_add_f32 v[14:15], v[14:15], v[132:133]
  v_pk_add_f32 v[14:15], v[14:15], v[134:135]
  v_pk_add_f32 v[14:15], v[14:15], v[136:137]
  v_pk_add_f32 v[14:15], v[14:15], v[138:139]
  v_pk_add_f32 v[14:15], v[14:15], v[140:141]
  v_pk_add_f32 v[14:15], v[14:15], v[142:143]
  v_pk_add_f32 v[14:15], v[14:15], v[144:145]
  v_pk_add_f32 v[14:15], v[14:15], v[146:147]
  v_pk_add_f32 v[14:15], v[14:15], v[148:149]
  v_pk_add_f32 v[14:15], v[14:15], v[150:151]
  v_pk_add_f32 v[14:15], v[14:15], v[152:153]
  v_pk_add_f32 v[14:15], v[14:15], v[154:155]
  v_pk_add_f32 v[14:15], v[14:15], v[156:157]
  v_pk_add_f32 v[14:15], v[14:15], v[158:159]
  v_add_f32 v14, v14, v15
  s_nop 1
  v_add_f32_dpp v14, v14, v14 row_ror:4 row_mask:0xf bank_mask:0xf
  s_nop 1
  v_add_f32_dpp v14, v14, v14 row_ror:8 row_mask:0xf bank_mask:0xf
  v_mov_b32 v15, v14
  s_nop 1
  v_permlane16_swap_b32 v14, v15
  v_add_f32 v14, v14, v15
  v_mov_b32 v15, v14
  s_nop 1
  v_permlane32_swap_b32 v14, v15
  v_add_f32 v14, v14, v15
  v_mul_f32 v14, 0x3b000000, v14
  v_pk_add_f32 v[128:129], v[128:129], v[14:15] op_sel_hi:[1,0] neg_lo:[0,1] neg_hi:[0,1]
  v_pk_add_f32 v[130:131], v[130:131], v[14:15] op_sel_hi:[1,0] neg_lo:[0,1] neg_hi:[0,1]
  v_pk_add_f32 v[132:133], v[132:133], v[14:15] op_sel_hi:[1,0] neg_lo:[0,1] neg_hi:[0,1]
  v_pk_add_f32 v[134:135], v[134:135], v[14:15] op_sel_hi:[1,0] neg_lo:[0,1] neg_hi:[0,1]
  v_pk_add_f32 v[136:137], v[136:137], v[14:15] op_sel_hi:[1,0] neg_lo:[0,1] neg_hi:[0,1]
  v_pk_add_f32 v[138:139], v[138:139], v[14:15] op_sel_hi:[1,0] neg_lo:[0,1] neg_hi:[0,1]
  v_pk_add_f32 v[140:141], v[140:141], v[14:15] op_sel_hi:[1,0] neg_lo:[0,1] neg_hi:[0,1]
  v_pk_add_f32 v[142:143], v[142:143], v[14:15] op_sel_hi:[1,0] neg_lo:[0,1] neg_hi:[0,1]
  v_pk_add_f32 v[144:145], v[144:145], v[14:15] op_sel_hi:[1,0] neg_lo:[0,1] neg_hi:[0,1]
  v_pk_add_f32 v[146:147], v[146:147], v[14:15] op_sel_hi:[1,0] neg_lo:[0,1] neg_hi:[0,1]
  v_pk_add_f32 v[148:149], v[148:149], v[14:15] op_sel_hi:[1,0] neg_lo:[0,1] neg_hi:[0,1]
  v_pk_add_f32 v[150:151], v[150:151], v[14:15] op_sel_hi:[1,0] neg_lo:[0,1] neg_hi:[0,1]
  v_pk_add_f32 v[152:153], v[152:153], v[14:15] op_sel_hi:[1,0] neg_lo:[0,1] neg_hi:[0,1]
  v_pk_add_f32 v[154:155], v[154:155], v[14:15] op_sel_hi:[1,0] neg_lo:[0,1] neg_hi:[0,1]
  v_pk_add_f32 v[156:157], v[156:157], v[14:15] op_sel_hi:[1,0] neg_lo:[0,1] neg_hi:[0,1]
  v_pk_add_f32 v[158:159], v[158:159], v[14:15] op_sel_hi:[1,0] neg_lo:[0,1] neg_hi:[0,1]
  v_pk_mul_f32 v[16:17], v[128:129], v[128:129]
  v_pk_fma_f32 v[16:17], v[130:131], v[130:131], v[16:17]
  v_pk_fma_f32 v[16:17], v[132:133], v[132:133], v[16:17]
  v_pk_fma_f32 v[16:17], v[134:135], v[134:135], v[16:17]
  v_pk_fma_f32 v[16:17], v[136:137], v[136:137], v[16:17]
  v_pk_fma_f32 v[16:17], v[138:139], v[138:139], v[16:17]
  v_pk_fma_f32 v[16:17], v[140:141], v[140:141], v[16:17]
  v_pk_fma_f32 v[16:17], v[142:143], v[142:143], v[16:17]
  v_pk_fma_f32 v[16:17], v[144:145], v[144:145], v[16:17]
  v_pk_fma_f32 v[16:17], v[146:147], v[146:147], v[16:17]
  v_pk_fma_f32 v[16:17], v[148:149], v[148:149], v[16:17]
  v_pk_fma_f32 v[16:17], v[150:151], v[150:151], v[16:17]
  v_pk_fma_f32 v[16:17], v[152:153], v[152:153], v[16:17]
  v_pk_fma_f32 v[16:17], v[154:155], v[154:155], v[16:17]
  v_pk_fma_f32 v[16:17], v[156:157], v[156:157], v[16:17]
  v_pk_fma_f32 v[16:17], v[158:159], v[158:159], v[16:17]
  v_add_f32 v15, v16, v17
  s_nop 1
  v_add_f32_dpp v15, v15, v15 row_ror:4 row_mask:0xf bank_mask:0xf
  s_nop 1
  v_add_f32_dpp v15, v15, v15 row_ror:8 row_mask:0xf bank_mask:0xf
  v_mov_b32 v16, v15
  s_nop 1
  v_permlane16_swap_b32 v15, v16
  v_add_f32 v15, v15, v16
  v_mov_b32 v16, v15
  s_nop 1
  v_permlane32_swap_b32 v15, v16
  v_add_f32 v15, v15, v16
  v_mul_f32 v15, 0x3b000000, v15
  v_cvt_pk_bf16_f32 v16, v14, v15
  v_lshlrev_b32 v14, 16, v16
  v_and_b32 v15, 0xffff0000, v16
  v_add_f32 v15, 0x3727c5ac, v15
  v_cvt_pk_bf16_f32 v15, v15, v15
  v_and_b32 v15, 0xffff0000, v15
  v_sqrt_f32 v15, v15
  s_nop 0
  v_cvt_pk_bf16_f32 v15, v15, v15
  v_and_b32 v15, 0xffff0000, v15
  v_rcp_f32 v16, v15
  s_waitcnt vmcnt(16)
  v_lshlrev_b32 v40, 16, v32
  v_and_b32 v41, 0xffff0000, v32
  v_lshlrev_b32 v42, 16, v33
  v_and_b32 v43, 0xffff0000, v33
  v_lshlrev_b32 v44, 16, v34
  v_and_b32 v45, 0xffff0000, v34
  v_lshlrev_b32 v46, 16, v35
  v_and_b32 v47, 0xffff0000, v35
  v_sub_f32 v40, v40, v14
  v_sub_f32 v41, v41, v14
  v_sub_f32 v42, v42, v14
  v_sub_f32 v43, v43, v14
  v_sub_f32 v44, v44, v14
  v_sub_f32 v45, v45, v14
  v_sub_f32 v46, v46, v14
  v_sub_f32 v47, v47, v14
  v_cvt_pk_bf16_f32 v17, v40, v41
  v_lshlrev_b32 v40, 16, v17
  v_and_b32 v41, 0xffff0000, v17
  v_cvt_pk_bf16_f32 v17, v42, v43
  v_lshlrev_b32 v42, 16, v17
  v_and_b32 v43, 0xffff0000, v17
  v_cvt_pk_bf16_f32 v17, v44, v45
  v_lshlrev_b32 v44, 16, v17
  v_and_b32 v45, 0xffff0000, v17
  v_cvt_pk_bf16_f32 v17, v46, v47
  v_lshlrev_b32 v46, 16, v17
  v_and_b32 v47, 0xffff0000, v17
  v_mul_f32 v18, v40, v16
  v_mul_f32 v19, v41, v16
  v_mul_f32 v20, v42, v16
  v_mul_f32 v21, v43, v16
  v_mul_f32 v22, v44, v16
  v_mul_f32 v23, v45, v16
  v_mul_f32 v24, v46, v16
  v_mul_f32 v25, v47, v16
  v_fma_f32 v40, -v18, v15, v40
  v_fma_f32 v41, -v19, v15, v41
  v_fma_f32 v42, -v20, v15, v42
  v_fma_f32 v43, -v21, v15, v43
  v_fma_f32 v44, -v22, v15, v44
  v_fma_f32 v45, -v23, v15, v45
  v_fma_f32 v46, -v24, v15, v46
  v_fma_f32 v47, -v25, v15, v47
  v_fma_f32 v40, v40, v16, v18
  v_fma_f32 v41, v41, v16, v19
  v_fma_f32 v42, v42, v16, v20
  v_fma_f32 v43, v43, v16, v21
  v_fma_f32 v44, v44, v16, v22
  v_fma_f32 v45, v45, v16, v23
  v_fma_f32 v46, v46, v16, v24
  v_fma_f32 v47, v47, v16, v25
  v_cvt_pk_bf16_f32 v17, v40, v41
  v_lshlrev_b32 v40, 16, v17
  v_and_b32 v41, 0xffff0000, v17
  v_cvt_pk_bf16_f32 v17, v42, v43
  v_lshlrev_b32 v42, 16, v17
  v_and_b32 v43, 0xffff0000, v17
  v_cvt_pk_bf16_f32 v17, v44, v45
  v_lshlrev_b32 v44, 16, v17
  v_and_b32 v45, 0xffff0000, v17
  v_cvt_pk_bf16_f32 v17, v46, v47
  v_lshlrev_b32 v46, 16, v17
  v_and_b32 v47, 0xffff0000, v17
  s_waitcnt lgkmcnt(0)
  s_and_b32 s94, s37, 0x7f7f7f7f
  s_add_u32 s94, s94, 0x3d275b01
  s_xor_b32 s37, s37, 0x3da75b01
  s_and_b32 s37, s37, 0x80808080
  s_xor_b32 s37, s37, s94
  s_bfe_u32 s94, s37, 0x00080000
  s_bfe_u32 s95, s37, 0x00080008
  s_bfe_u32 s96, s37, 0x00080010
  s_bfe_u32 s97, s37, 0x00080018
  v_mov_b32 v63, s37
  s_waitcnt vmcnt(8)
  v_perm_b32 v128, v68, v64, s38
  v_perm_b32 v129, v76, v72, s38
  v_perm_b32 v130, v84, v80, s38
  v_perm_b32 v131, v92, v88, s38
  v_perm_b32 v132, v68, v64, s39
  v_perm_b32 v133, v76, v72, s39
  v_perm_b32 v134, v84, v80, s39
  v_perm_b32 v135, v92, v88, s39
  v_perm_b32 v136, v69, v65, s38
  v_perm_b32 v137, v77, v73, s38
  v_perm_b32 v138, v85, v81, s38
  v_perm_b32 v139, v93, v89, s38
  v_perm_b32 v140, v69, v65, s39
  v_perm_b32 v141, v77, v73, s39
  v_perm_b32 v142, v85, v81, s39
  v_perm_b32 v143, v93, v89, s39
  v_perm_b32 v144, v70, v66, s38
  v_perm_b32 v145, v78, v74, s38
  v_perm_b32 v146, v86, v82, s38
  v_perm_b32 v147, v94, v90, s38
  v_perm_b32 v148, v70, v66, s39
  v_perm_b32 v149, v78, v74, s39
  v_perm_b32 v150, v86, v82, s39
  v_perm_b32 v151, v94, v90, s39
  v_perm_b32 v152, v71, v67, s38
  v_perm_b32 v153, v79, v75, s38
  v_perm_b32 v154, v87, v83, s38
  v_perm_b32 v155, v95, v91, s38
  v_perm_b32 v156, v71, v67, s39
  v_perm_b32 v157, v79, v75, s39
  v_perm_b32 v158, v87, v83, s39
  v_perm_b32 v159, v95, v91, s39
  s_waitcnt vmcnt(0)
  v_perm_b32 v160, v100, v96, s38
  v_perm_b32 v161, v108, v104, s38
  v_perm_b32 v162, v116, v112, s38
  v_perm_b32 v163, v124, v120, s38
  v_perm_b32 v164, v100, v96, s39
  v_perm_b32 v165, v108, v104, s39
  v_perm_b32 v166, v116, v112, s39
  v_perm_b32 v167, v124, v120, s39
  v_perm_b32 v168, v101, v97, s38
  v_perm_b32 v169, v109, v105, s38
  v_perm_b32 v170, v117, v113, s38
  v_perm_b32 v171, v125, v121, s38
  v_perm_b32 v172, v101, v97, s39
  v_perm_b32 v173, v109, v105, s39
  v_perm_b32 v174, v117, v113, s39
  v_perm_b32 v175, v125, v121, s39
  v_perm_b32 v176, v102, v98, s38
  v_perm_b32 v177, v110, v106, s38
  v_perm_b32 v178, v118, v114, s38
  v_perm_b32 v179, v126, v122, s38
  v_perm_b32 v180, v102, v98, s39
  v_perm_b32 v181, v110, v106, s39
  v_perm_b32 v182, v118, v114, s39
  v_perm_b32 v183, v126, v122, s39
  v_perm_b32 v184, v103, v99, s38
  v_perm_b32 v185, v111, v107, s38
  v_perm_b32 v186, v119, v115, s38
  v_perm_b32 v187, v127, v123, s38
  v_perm_b32 v188, v103, v99, s39
  v_perm_b32 v189, v111, v107, s39
  v_perm_b32 v190, v119, v115, s39
  v_perm_b32 v191, v127, v123, s39
  s_mov_b32 s44, s12
  s_and_b32 s45, s13, 0xffff
  s_mov_b32 s46, 0x00400000
  s_mov_b32 s47, 0x20000
  v_lshrrev_b32 v62, 3, v2
  v_lshlrev_b32 v62, 3, v62
  v_lshl_add_u32 v62, v1, 4, v62
  v_lshlrev_b32 v62, 10, v62
  v_and_b32 v61, 7, v2
  v_lshl_add_u32 v62, v61, 4, v62
  s_lshl_b32 s63, s32, 19
  s_lshl_b32 s56, s36, 17
  s_add_u32 s63, s63, s56
  s_xor_b32 s56, s35, 4
  s_lshl_b32 s56, s56, 7
  s_add_u32 s63, s63, s56
  s_add_u32 s56, s63, 0
  buffer_load_dwordx4 v[64:67], v62, s[44:47], s56 offen offset:0
  buffer_load_dwordx4 v[68:71], v62, s[44:47], s56 offen offset:1024
  s_waitcnt vmcnt(1)
  buffer_load_dwordx4 v[72:75], v62, s[44:47], s56 offen offset:2048
  s_waitcnt vmcnt(1)
  buffer_load_dwordx4 v[76:79], v62, s[44:47], s56 offen offset:3072
  s_lshl_b32 s55, s58, 11
  s_add_u32 s55, s55, 1966080
  s_add_u32 s56, s55, 8192
  s_mov_b32 s59, s60
  s_lshl_b32 s57, s32, 2
  s_add_u32 s57, s57, s58
  s_lshl_b32 s57, s57, 7
  s_add_u32 s57, s57, 2031616
  s_add_u32 s60, s30, s57
  s_addc_u32 s61, s31, 0
  s_mov_b32 s52, 1
  s_branch L_modp_9_go
L_modp_9:
  s_add_u32 s52, s52, 1
  s_cmp_gt_u32 s52, 400000
  s_cbranch_scc1 L_end
L_modp_9_go:
  s_load_dwordx4 s[8:11], s[60:61], 0 glc
  s_waitcnt lgkmcnt(0)
  s_xor_b32 s6, s8, s37
  s_xor_b32 s9, s9, s37
  s_or_b32 s6, s6, s9
  s_xor_b32 s10, s10, s37
  s_or_b32 s6, s6, s10
  s_xor_b32 s11, s11, s37
  s_or_b32 s6, s6, s11
  s_cbranch_scc1 L_modp_9
  s_mov_b32 s60, s59
  s_lshl_b32 s57, s32, 7
  s_add_u32 s57, s57, 2039808
  v_and_b32 v20, 31, v0
  v_lshlrev_b32 v20, 2, v20
  s_getreg_b32 s62, hwreg(HW_REG_XCC_ID, 0, 4)
  s_and_b32 s58, s37, 0xfffffff0
  s_or_b32 s62, s62, s58
  s_mov_b32 s52, 1
  s_branch L_modpoll_10_go
L_modpoll_10:
  s_add_u32 s52, s52, 1
  s_cmp_gt_u32 s52, 400000
  s_cbranch_scc1 L_end
L_modpoll_10_go:
  buffer_load_dword v21, v20, s[40:43], s57 offen sc1
  buffer_load_dwordx4 v[224:227], v13, s[40:43], s55 offen sc1
  buffer_load_dwordx4 v[228:231], v13, s[40:43], s55 offen offset:512 sc1
  buffer_load_dwordx4 v[232:235], v13, s[40:43], s56 offen sc1
  buffer_load_dwordx4 v[236:239], v13, s[40:43], s56 offen offset:512 sc1
  s_waitcnt vmcnt(0)
  v_xor_b32 v14, s37, v225
  v_xor_b32 v15, s37, v227
  v_or_b32 v14, v14, v15
  v_xor_b32 v15, s37, v229
  v_or_b32 v14, v14, v15
  v_xor_b32 v15, s37, v231
  v_or_b32 v14, v14, v15
  v_xor_b32 v15, s37, v233
  v_or_b32 v14, v14, v15
  v_xor_b32 v15, s37, v235
  v_or_b32 v14, v14, v15
  v_xor_b32 v15, s37, v237
  v_or_b32 v14, v14, v15
  v_xor_b32 v15, s37, v239
  v_or_b32 v14, v14, v15
  v_cmp_ne_u32 vcc, 0, v14
  s_cbranch_vccnz L_modpoll_10
  v_cmp_ne_u32 vcc, s62, v21
  s_nop 0
  s_cmp_eq_u64 vcc, 0
  s_cselect_b32 s62, 2, 1
  v_lshlrev_b32 v16, 16, v232
  v_and_b32 v17, 0xffff0000, v232
  v_lshlrev_b32 v18, 16, v234
  v_and_b32 v19, 0xffff0000, v234
  v_lshlrev_b32 v20, 16, v236
  v_and_b32 v21, 0xffff0000, v236
  v_lshlrev_b32 v22, 16, v238
  v_and_b32 v23, 0xffff0000, v238
  v_add_f32 v16, 1.0, v16
  v_add_f32 v17, 1.0, v17
  v_add_f32 v18, 1.0, v18
  v_add_f32 v19, 1.0, v19
  v_add_f32 v20, 1.0, v20
  v_add_f32 v21, 1.0, v21
  v_add_f32 v22, 1.0, v22
  v_add_f32 v23, 1.0, v23
  v_cvt_pk_bf16_f32 v14, v16, v17
  v_lshlrev_b32 v16, 16, v14
  v_and_b32 v17, 0xffff0000, v14
  v_cvt_pk_bf16_f32 v14, v18, v19
  v_lshlrev_b32 v18, 16, v14
  v_and_b32 v19, 0xffff0000, v14
  v_cvt_pk_bf16_f32 v14, v20, v21
  v_lshlrev_b32 v20, 16, v14
  v_and_b32 v21, 0xffff0000, v14
  v_cvt_pk_bf16_f32 v14, v22, v23
  v_lshlrev_b32 v22, 16, v14
  v_and_b32 v23, 0xffff0000, v14
  v_pk_mul_f32 v[16:17], v[16:17], v[40:41]
  v_pk_mul_f32 v[18:19], v[18:19], v[42:43]
  v_pk_mul_f32 v[20:21], v[20:21], v[44:45]
  v_pk_mul_f32 v[22:23], v[22:23], v[46:47]
  v_cvt_pk_bf16_f32 v14, v16, v17
  v_lshlrev_b32 v16, 16, v14
  v_and_b32 v17, 0xffff0000, v14
  v_cvt_pk_bf16_f32 v14, v18, v19
  v_lshlrev_b32 v18, 16, v14
  v_and_b32 v19, 0xffff0000, v14
  v_cvt_pk_bf16_f32 v14, v20, v21
  v_lshlrev_b32 v20, 16, v14
  v_and_b32 v21, 0xffff0000, v14
  v_cvt_pk_bf16_f32 v14, v22, v23
  v_lshlrev_b32 v22, 16, v14
  v_and_b32 v23, 0xffff0000, v14
  v_lshlrev_b32 v24, 16, v224
  v_and_b32 v25, 0xffff0000, v224
  v_lshlrev_b32 v26, 16, v226
  v_and_b32 v27, 0xffff0000, v226
  v_lshlrev_b32 v28, 16, v228
  v_and_b32 v29, 0xffff0000, v228
  v_lshlrev_b32 v30, 16, v230
  v_and_b32 v31, 0xffff0000, v230
  v_pk_add_f32 v[16:17], v[16:17], v[24:25]
  v_pk_add_f32 v[18:19], v[18:19], v[26:27]
  v_pk_add_f32 v[20:21], v[20:21], v[28:29]
  v_pk_add_f32 v[22:23], v[22:23], v[30:31]
  v_cvt_pk_bf16_f32 v36, v16, v17
  v_cvt_pk_bf16_f32 v37, v18, v19
  v_cvt_pk_bf16_f32 v38, v20, v21
  v_cvt_pk_bf16_f32 v39, v22, v23
  v_mov_b32_dpp v32, v36 row_ror:8 row_mask:0xf bank_mask:0xf
  v_mov_b32_dpp v33, v37 row_ror:8 row_mask:0xf bank_mask:0xf
  v_mov_b32_dpp v34, v38 row_ror:8 row_mask:0xf bank_mask:0xf
  v_mov_b32_dpp v35, v39 row_ror:8 row_mask:0xf bank_mask:0xf
  v_mfma_f32_16x16x32_bf16 v[192:195], v[36:39], v[128:131], 0
  v_mfma_f32_16x16x32_bf16 v[196:199], v[36:39], v[132:135], 0
  v_mfma_f32_16x16x32_bf16 v[200:203], v[36:39], v[136:139], 0
  v_mfma_f32_16x16x32_bf16 v[204:207], v[36:39], v[140:143], 0
  v_mfma_f32_16x16x32_bf16 v[208:211], v[36:39], v[144:147], 0
  v_mfma_f32_16x16x32_bf16 v[212:215], v[36:39], v[148:151], 0
  v_mfma_f32_16x16x32_bf16 v[216:219], v[36:39], v[152:155], 0
  v_mfma_f32_16x16x32_bf16 v[220:223], v[36:39], v[156:159], 0
  v_mfma_f32_16x16x32_bf16 v[192:195], v[32:35], v[160:163], v[192:195]
  v_mfma_f32_16x16x32_bf16 v[196:199], v[32:35], v[164:167], v[196:199]
  v_mfma_f32_16x16x32_bf16 v[200:203], v[32:35], v[168:171], v[200:203]
  v_mfma_f32_16x16x32_bf16 v[204:207], v[32:35], v[172:175], v[204:207]
  v_mfma_f32_16x16x32_bf16 v[208:211], v[32:35], v[176:179], v[208:211]
  v_mfma_f32_16x16x32_bf16 v[212:215], v[32:35], v[180:183], v[212:215]
  v_mfma_f32_16x16x32_bf16 v[216:219], v[32:35], v[184:187], v[216:219]
  v_mfma_f32_16x16x32_bf16 v[220:223], v[32:35], v[188:191], v[220:223]
  v_lshlrev_b32 v12, 14, v1
  v_lshl_add_u32 v12, v2, 4, v12
  v_and_b32 v4, 7, v0
  v_lshlrev_b32 v4, 7, v4
  v_lshl_add_u32 v4, v1, 10, v4
  v_add_u32 v6, s53, v4
  v_lshlrev_b32 v4, 6, v2
  v_lshl_add_u32 v4, v1, 2, v4
  v_add_u32 v4, s53, v4
  v_add_u32 v5, 1024, v4
  s_mov_b32 exec_lo, 0xff0000ff
  s_mov_b32 exec_hi, 0
  ds_write_b128 v6, v[192:195] offset:0
  ds_write_b128 v6, v[196:199] offset:16
  ds_write_b128 v6, v[200:203] offset:32
  ds_write_b128 v6, v[204:207] offset:48
  ds_write_b128 v6, v[208:211] offset:64
  ds_write_b128 v6, v[212:215] offset:80
  ds_write_b128 v6, v[216:219] offset:96
  ds_write_b128 v6, v[220:223] offset:112
  s_mov_b64 exec, -1
  s_waitcnt lgkmcnt(0)
  ds_read2_b32 v[16:17], v4 offset0:0 offset1:4
  ds_read2_b32 v[18:19], v4 offset0:8 offset1:12
  ds_read2_b32 v[20:21], v5 offset0:0 offset1:4
  ds_read2_b32 v[22:23], v5 offset0:8 offset1:12
  s_waitcnt lgkmcnt(0)
  v_pk_add_f32 v[16:17], v[16:17], v[20:21]
  v_pk_add_f32 v[18:19], v[18:19], v[22:23]
  v_perm_b32 v16, v16, v63, s98
  v_perm_b32 v17, v17, v63, s99
  v_perm_b32 v18, v18, v63, s100
  v_perm_b32 v19, v19, v63, s101
  s_cmp_eq_u32 s62, 2
  s_cbranch_scc0 L_sr_11
  buffer_store_dwordx4 v[16:19], v12, s[40:43], s60 offen
  s_branch L_sd_12
L_sr_11:
  buffer_store_dwordx4 v[16:19], v12, s[40:43], s60 offen sc1
L_sd_12:
  s_lshl_b32 s55, s32, 9
  s_add_u32 s55, s55, s33
  s_add_u32 s55, s55, 2035712
  v_lshlrev_b32 v4, 7, v0
  s_mov_b64 exec, 0xf
  buffer_store_byte v63, v4, s[40:43], s55 offen sc1
  s_mov_b64 exec, -1
  s_add_u32 s56, s63, 4096
  buffer_load_dwordx4 v[80:83], v62, s[44:47], s56 offen offset:0
  s_waitcnt vmcnt(1)
  buffer_load_dwordx4 v[84:87], v62, s[44:47], s56 offen offset:1024
  s_lshl_b32 s55, s34, 14
  s_lshl_b32 s56, s32, 11
  s_add_u32 s55, s55, s56
  s_add_u32 s55, s55, 65536
  s_lshl_b32 s57, s32, 2
  s_add_u32 s57, s57, s34
  s_lshl_b32 s57, s57, 7
  s_add_u32 s57, s57, 2035712
  s_mul_i32 s58, s94, 0x01010101
  s_add_u32 s60, s30, s57
  s_addc_u32 s61, s31, 0
  s_mov_b32 s52, 1
  s_branch L_qp_13_go
L_qp_13:
  s_add_u32 s52, s52, 1
  s_cmp_gt_u32 s52, 400000
  s_cbranch_scc1 L_end
L_qp_13_go:
  s_load_dwordx8 s[8:15], s[60:61], 0 glc
  s_waitcnt lgkmcnt(0)
  s_xor_b32 s6, s8, s58
  s_xor_b32 s9, s9, s58
  s_or_b32 s6, s6, s9
  s_xor_b32 s10, s10, s58
  s_or_b32 s6, s6, s10
  s_xor_b32 s11, s11, s58
  s_or_b32 s6, s6, s11
  s_xor_b32 s12, s12, s58
  s_or_b32 s6, s6, s12
  s_xor_b32 s13, s13, s58
  s_or_b32 s6, s6, s13
  s_xor_b32 s14, s14, s58
  s_or_b32 s6, s6, s14
  s_xor_b32 s15, s15, s58
  s_or_b32 s6, s6, s15
  s_cbranch_scc1 L_qp_13
  s_add_u32 s56, s55, 0x10000
  s_add_u32 s57, s55, 0x20000
  s_add_u32 s58, s55, 0x30000
  s_mov_b32 s52, 1
  s_branch L_qpoll_14_go
L_qpoll_14:
  s_add_u32 s52, s52, 1
  s_cmp_gt_u32 s52, 400000
  s_cbranch_scc1 L_end
L_qpoll_14_go:
  buffer_load_dwordx4 v[16:19], v3, s[40:43], s55 offen sc1
  buffer_load_dwordx4 v[20:23], v3, s[40:43], s55 offen offset:1024 sc1
  buffer_load_dwordx4 v[24:27], v3, s[40:43], s56 offen sc1
  buffer_load_dwordx4 v[28:31], v3, s[40:43], s56 offen offset:1024 sc1
  buffer_load_dwordx4 v[32:35], v3, s[40:43], s57 offen sc1
  buffer_load_dwordx4 v[36:39], v3, s[40:43], s57 offen offset:1024 sc1
  buffer_load_dwordx4 v[40:43], v3, s[40:43], s58 offen sc1
  buffer_load_dwordx4 v[44:47], v3, s[40:43], s58 offen offset:1024 sc1
  s_waitcnt vmcnt(0)
  v_xor_b32 v16, s94, v16
  v_xor_b32 v17, s95, v17
  v_xor_b32 v18, s96, v18
  v_xor_b32 v19, s97, v19
  v_xor_b32 v20, s94, v20
  v_xor_b32 v21, s95, v21
  v_xor_b32 v22, s96, v22
  v_xor_b32 v23, s97, v23
  v_xor_b32 v24, s94, v24
  v_xor_b32 v25, s95, v25
  v_xor_b32 v26, s96, v26
  v_xor_b32 v27, s97, v27
  v_xor_b32 v28, s94, v28
  v_xor_b32 v29, s95, v29
  v_xor_b32 v30, s96, v30
  v_xor_b32 v31, s97, v31
  v_xor_b32 v32, s94, v32
  v_xor_b32 v33, s95, v33
  v_xor_b32 v34, s96, v34
  v_xor_b32 v35, s97, v35
  v_xor_b32 v36, s94, v36
  v_xor_b32 v37, s95, v37
  v_xor_b32 v38, s96, v38
  v_xor_b32 v39, s97, v39
  v_xor_b32 v40, s94, v40
  v_xor_b32 v41, s95, v41
  v_xor_b32 v42, s96, v42
  v_xor_b32 v43, s97, v43
  v_xor_b32 v44, s94, v44
  v_xor_b32 v45, s95, v45
  v_xor_b32 v46, s96, v46
  v_xor_b32 v47, s97, v47
  v_or3_b32 v12, v16, v18, v20
  v_or3_b32 v13, v17, v19, v21
  v_or3_b32 v12, v12, v22, v24
  v_or3_b32 v13, v13, v23, v25
  v_or3_b32 v12, v12, v26, v28
  v_or3_b32 v13, v13, v27, v29
  v_or3_b32 v12, v12, v30, v32
  v_or3_b32 v13, v13, v31, v33
  v_or3_b32 v12, v12, v34, v36
  v_or3_b32 v13, v13, v35, v37
  v_or3_b32 v12, v12, v38, v40
  v_or3_b32 v13, v13, v39, v41
  v_or3_b32 v12, v12, v42, v44
  v_or3_b32 v13, v13, v43, v45
  v_or_b32 v12, v12, v46
  v_or_b32 v13, v13, v47
  v_or_b32 v12, v12, v13
  v_and_b32 v12, 0xff, v12
  v_cmp_ne_u32 vcc, 0, v12
  s_cbranch_vccnz L_qpoll_14
  v_pk_add_f32 v[16:17], v[16:17], v[24:25]
  v_pk_add_f32 v[32:33], v[32:33], v[40:41]
  v_pk_add_f32 v[18:19], v[18:19], v[26:27]
  v_pk_add_f32 v[34:35], v[34:35], v[42:43]
  v_pk_add_f32 v[20:21], v[20:21], v[28:29]
  v_pk_add_f32 v[36:37], v[36:37], v[44:45]
  v_pk_add_f32 v[22:23], v[22:23], v[30:31]
  v_pk_add_f32 v[38:39], v[38:39], v[46:47]
  v_pk_add_f32 v[16:17], v[16:17], v[32:33]
  v_pk_add_f32 v[18:19], v[18:19], v[34:35]
  v_pk_add_f32 v[20:21], v[20:21], v[36:37]
  v_pk_add_f32 v[22:23], v[22:23], v[38:39]
  v_cvt_pk_bf16_f32 v8, v16, v17
  v_cvt_pk_bf16_f32 v9, v18, v19
  v_cvt_pk_bf16_f32 v10, v20, v21
  v_cvt_pk_bf16_f32 v11, v22, v23
  v_lshlrev_b32 v4, 3, v0
  v_add_u32 v4, 131072, v4
  ds_write_b64 v4, v[8:9]
  ds_write_b64 v4, v[10:11] offset:512
  v_mov_b32 v4, 157888
  v_mov_b32 v5, s62
  ds_write_b32 v4, v63 offset:12
  s_waitcnt lgkmcnt(0)
  ds_write_b32 v4, v5
  s_add_u32 s56, s63, 4096
  buffer_load_dwordx4 v[88:91], v62, s[44:47], s56 offen offset:2048
  buffer_load_dwordx4 v[92:95], v62, s[44:47], s56 offen offset:3072
  s_add_u32 s56, s63, 65536
  buffer_load_dwordx4 v[96:99], v62, s[44:47], s56 offen offset:0
  buffer_load_dwordx4 v[100:103], v62, s[44:47], s56 offen offset:1024
  s_waitcnt vmcnt(3)
  buffer_load_dwordx4 v[104:107], v62, s[44:47], s56 offen offset:2048
  s_waitcnt vmcnt(3)
  buffer_load_dwordx4 v[108:111], v62, s[44:47], s56 offen offset:3072
  s_add_u32 s56, s63, 69632
  s_waitcnt vmcnt(3)
  buffer_load_dwordx4 v[112:115], v62, s[44:47], s56 offen offset:0
  s_waitcnt vmcnt(3)
  buffer_load_dwordx4 v[116:119], v62, s[44:47], s56 offen offset:1024
  s_waitcnt vmcnt(3)
  buffer_load_dwordx4 v[120:123], v62, s[44:47], s56 offen offset:2048
  s_waitcnt vmcnt(3)
  buffer_load_dwordx4 v[124:127], v62, s[44:47], s56 offen offset:3072
  s_branch L_midB
L_Ared0:
  s_waitcnt lgkmcnt(0)
  s_and_b32 s94, s37, 0x7f7f7f7f
  s_add_u32 s94, s94, 0x3d275b01
  s_xor_b32 s37, s37, 0x3da75b01
  s_and_b32 s37, s37, 0x80808080
  s_xor_b32 s37, s37, s94
  s_bfe_u32 s94, s37, 0x00080000
  s_bfe_u32 s95, s37, 0x00080008
  s_bfe_u32 s96, s37, 0x00080010
  s_bfe_u32 s97, s37, 0x00080018
  v_mov_b32 v63, s37
  s_mov_b32 s44, s12
  s_and_b32 s45, s13, 0xffff
  s_mov_b32 s46, 0x00400000
  s_mov_b32 s47, 0x20000
  v_lshrrev_b32 v62, 3, v2
  v_lshlrev_b32 v62, 3, v62
  v_lshl_add_u32 v62, v1, 4, v62
  v_lshlrev_b32 v62, 10, v62
  v_and_b32 v61, 7, v2
  v_lshl_add_u32 v62, v61, 4, v62
  s_lshl_b32 s63, s32, 19
  s_lshl_b32 s56, s36, 17
  s_add_u32 s63, s63, s56
  s_xor_b32 s56, s35, 4
  s_lshl_b32 s56, s56, 7
  s_add_u32 s63, s63, s56
  s_mov_b32 s62, s54
  s_lshl_b32 s55, s62, 13
  s_add_u32 s55, s55, 1572864
  s_add_u32 s58, s55, 4096
  v_lshlrev_b32 v3, 4, v0
  v_and_b32 v5, 1, v2
  v_lshlrev_b32 v5, 9, v5
  v_lshl_add_u32 v5, v1, 7, v5
  v_lshrrev_b32 v4, 1, v2
  v_lshl_add_u32 v5, v4, 4, v5
  s_lshl_b32 s60, s62, 10
  s_add_u32 s60, s60, 1966080
  s_mov_b32 s59, s60
  s_mov_b32 s62, s63
  s_add_u32 s60, s30, s55
  s_addc_u32 s61, s31, 0
  s_mov_b32 s52, 1
  s_branch L_arp_15_go
L_arp_15:
  s_add_u32 s52, s52, 1
  s_cmp_gt_u32 s52, 400000
  s_cbranch_scc1 L_end
L_arp_15_go:
  s_load_dword s6, s[60:61], 1008 glc
  s_load_dword s7, s[60:61], 2032 glc
  s_load_dword s8, s[60:61], 3056 glc
  s_load_dword s9, s[60:61], 4080 glc
  s_load_dword s10, s[60:61], 5104 glc
  s_load_dword s11, s[60:61], 6128 glc
  s_load_dword s14, s[60:61], 7152 glc
  s_load_dword s15, s[60:61], 8176 glc
  s_waitcnt lgkmcnt(0)
  s_xor_b32 s63, s6, s94
  s_xor_b32 s7, s7, s94
  s_or_b32 s63, s63, s7
  s_xor_b32 s8, s8, s94
  s_or_b32 s63, s63, s8
  s_xor_b32 s9, s9, s94
  s_or_b32 s63, s63, s9
  s_xor_b32 s10, s10, s94
  s_or_b32 s63, s63, s10
  s_xor_b32 s11, s11, s94
  s_or_b32 s63, s63, s11
  s_xor_b32 s14, s14, s94
  s_or_b32 s63, s63, s14
  s_xor_b32 s15, s15, s94
  s_or_b32 s63, s63, s15
  s_and_b32 s63, s63, 0xff
  s_cbranch_scc1 L_arp_15
  s_mov_b32 s60, s59
  s_mov_b32 s63, s62
  s_add_u32 s58, s55, 4096
  s_mov_b32 s52, 1
  s_branch L_ared_16_go
L_ared_16:
  s_add_u32 s52, s52, 1
  s_cmp_gt_u32 s52, 400000
  s_cbranch_scc1 L_end
L_ared_16_go:
  buffer_load_dwordx4 v[16:19], v3, s[40:43], s55 offen offset:0 sc1
  buffer_load_dwordx4 v[20:23], v3, s[40:43], s55 offen offset:1024 sc1
  buffer_load_dwordx4 v[24:27], v3, s[40:43], s55 offen offset:2048 sc1
  buffer_load_dwordx4 v[28:31], v3, s[40:43], s55 offen offset:3072 sc1
  buffer_load_dwordx4 v[32:35], v3, s[40:43], s58 offen offset:0 sc1
  buffer_load_dwordx4 v[36:39], v3, s[40:43], s58 offen offset:1024 sc1
  buffer_load_dwordx4 v[40:43], v3, s[40:43], s58 offen offset:2048 sc1
  buffer_load_dwordx4 v[44:47], v3, s[40:43], s58 offen offset:3072 sc1
  s_waitcnt vmcnt(0)
  v_xor_b32 v16, s94, v16
  v_xor_b32 v17, s95, v17
  v_xor_b32 v18, s96, v18
  v_xor_b32 v19, s97, v19
  v_xor_b32 v20, s94, v20
  v_xor_b32 v21, s95, v21
  v_xor_b32 v22, s96, v22
  v_xor_b32 v23, s97, v23
  v_xor_b32 v24, s94, v24
  v_xor_b32 v25, s95, v25
  v_xor_b32 v26, s96, v26
  v_xor_b32 v27, s97, v27
  v_xor_b32 v28, s94, v28
  v_xor_b32 v29, s95, v29
  v_xor_b32 v30, s96, v30
  v_xor_b32 v31, s97, v31
  v_xor_b32 v32, s94, v32
  v_xor_b32 v33, s95, v33
  v_xor_b32 v34, s96, v34
  v_xor_b32 v35, s97, v35
  v_xor_b32 v36, s94, v36
  v_xor_b32 v37, s95, v37
  v_xor_b32 v38, s96, v38
  v_xor_b32 v39, s97, v39
  v_xor_b32 v40, s94, v40
  v_xor_b32 v41, s95, v41
  v_xor_b32 v42, s96, v42
  v_xor_b32 v43, s97, v43
  v_xor_b32 v44, s94, v44
  v_xor_b32 v45, s95, v45
  v_xor_b32 v46, s96, v46
  v_xor_b32 v47, s97, v47
  v_or3_b32 v6, v16, v18, v20
  v_or3_b32 v7, v17, v19, v21
  v_or3_b32 v6, v6, v22, v24
  v_or3_b32 v7, v7, v23, v25
  v_or3_b32 v6, v6, v26, v28
  v_or3_b32 v7, v7, v27, v29
  v_or3_b32 v6, v6, v30, v32
  v_or3_b32 v7, v7, v31, v33
  v_or3_b32 v6, v6, v34, v36
  v_or3_b32 v7, v7, v35, v37
  v_or3_b32 v6, v6, v38, v40
  v_or3_b32 v7, v7, v39, v41
  v_or3_b32 v6, v6, v42, v44
  v_or3_b32 v7, v7, v43, v45
  v_or_b32 v6, v6, v46
  v_or_b32 v7, v7, v47
  v_or_b32 v6, v6, v7
  v_and_b32 v6, 0xff, v6
  v_cmp_ne_u32 vcc, 0, v6
  s_cbranch_vccnz L_ared_16
  v_pk_add_f32 v[16:17], v[16:17], v[20:21]
  v_pk_add_f32 v[18:19], v[18:19], v[22:23]
  v_pk_add_f32 v[24:25], v[24:25], v[28:29]
  v_pk_add_f32 v[26:27], v[26:27], v[30:31]
  v_pk_add_f32 v[32:33], v[32:33], v[36:37]
  v_pk_add_f32 v[34:35], v[34:35], v[38:39]
  v_pk_add_f32 v[40:41], v[40:41], v[44:45]
  v_pk_add_f32 v[42:43], v[42:43], v[46:47]
  v_pk_add_f32 v[16:17], v[16:17], v[24:25]
  v_pk_add_f32 v[18:19], v[18:19], v[26:27]
  v_pk_add_f32 v[32:33], v[32:33], v[40:41]
  v_pk_add_f32 v[34:35], v[34:35], v[42:43]
  v_pk_add_f32 v[16:17], v[16:17], v[32:33]
  v_pk_add_f32 v[18:19], v[18:19], v[34:35]
  v_cvt_pk_bf16_f32 v16, v16, v17
  v_cvt_pk_bf16_f32 v18, v18, v19
  v_mov_b32 v17, s37
  v_mov_b32 v19, s37
  buffer_store_dwordx4 v[16:19], v5, s[40:43], s60 offen sc1
  s_and_b32 s55, s54, 7
  s_lshr_b32 s55, s55, 1
  s_lshl_b32 s55, s55, 7
  s_lshr_b32 s56, s54, 3
  s_lshl_b32 s56, s56, 3
  s_add_u32 s55, s55, s56
  s_and_b32 s56, s54, 1
  s_lshl_b32 s56, s56, 2
  s_add_u32 s55, s55, s56
  s_add_u32 s55, s55, 2031616
  v_lshlrev_b32 v4, 9, v0
  s_mov_b64 exec, 0xff
  buffer_store_dword v63, v4, s[40:43], s55 offen sc1
  s_mov_b64 exec, -1
  s_add_u32 s56, s63, 0
  buffer_load_dwordx4 v[64:67], v62, s[44:47], s56 offen offset:0
  buffer_load_dwordx4 v[68:71], v62, s[44:47], s56 offen offset:1024
  s_waitcnt vmcnt(2)
  buffer_load_dwordx4 v[72:75], v62, s[44:47], s56 offen offset:2048
  s_waitcnt vmcnt(2)
  buffer_load_dwordx4 v[76:79], v62, s[44:47], s56 offen offset:3072
  s_add_u32 s56, s63, 4096
  s_waitcnt vmcnt(2)
  buffer_load_dwordx4 v[80:83], v62, s[44:47], s56 offen offset:0
  s_waitcnt vmcnt(2)
  buffer_load_dwordx4 v[84:87], v62, s[44:47], s56 offen offset:1024
  s_waitcnt vmcnt(2)
  buffer_load_dwordx4 v[88:91], v62, s[44:47], s56 offen offset:2048
  s_waitcnt vmcnt(2)
  buffer_load_dwordx4 v[92:95], v62, s[44:47], s56 offen offset:3072
  s_add_u32 s56, s63, 65536
  s_waitcnt vmcnt(2)
  buffer_load_dwordx4 v[96:99], v62, s[44:47], s56 offen offset:0
  s_waitcnt vmcnt(2)
  buffer_load_dwordx4 v[100:103], v62, s[44:47], s56 offen offset:1024
  s_waitcnt vmcnt(2)
  buffer_load_dwordx4 v[104:107], v62, s[44:47], s56 offen offset:2048
  s_waitcnt vmcnt(2)
  buffer_load_dwordx4 v[108:111], v62, s[44:47], s56 offen offset:3072
  s_add_u32 s56, s63, 69632
  s_waitcnt vmcnt(2)
  buffer_load_dwordx4 v[112:115], v62, s[44:47], s56 offen offset:0
  s_waitcnt vmcnt(2)
  buffer_load_dwordx4 v[116:119], v62, s[44:47], s56 offen offset:1024
  s_waitcnt vmcnt(2)
  buffer_load_dwordx4 v[120:123], v62, s[44:47], s56 offen offset:2048
  s_waitcnt vmcnt(2)
  buffer_load_dwordx4 v[124:127], v62, s[44:47], s56 offen offset:3072
  s_branch L_midB
L_idle:
  s_waitcnt lgkmcnt(0)
  s_and_b32 s94, s37, 0x7f7f7f7f
  s_add_u32 s94, s94, 0x3d275b01
  s_xor_b32 s37, s37, 0x3da75b01
  s_and_b32 s37, s37, 0x80808080
  s_xor_b32 s37, s37, s94
  s_bfe_u32 s94, s37, 0x00080000
  s_bfe_u32 s95, s37, 0x00080008
  s_bfe_u32 s96, s37, 0x00080010
  s_bfe_u32 s97, s37, 0x00080018
  v_mov_b32 v63, s37
  s_cmp_eq_u32 s36, 3
  s_cbranch_scc0 L_nxi_17
  s_getreg_b32 s55, hwreg(HW_REG_XCC_ID, 0, 4)
  s_and_b32 s56, s37, 0xfffffff0
  s_or_b32 s55, s55, s56
  v_mov_b32 v4, s55
  s_lshl_b32 s55, s32, 5
  s_add_u32 s55, s55, s33
  s_lshl_b32 s55, s55, 2
  s_add_u32 s55, s55, 2039808
  v_mov_b32 v5, 0
  s_mov_b64 exec, 1
  buffer_store_dword v4, v5, s[40:43], s55 offen sc1
  s_mov_b64 exec, -1
L_nxi_17:
L_mid:
  s_cmp_eq_u32 s35, 7
  s_cbranch_scc1 L_w_final
  s_mul_i32 s59, s32, 7
  s_add_u32 s59, s59, s35
  s_mov_b32 s44, s12
  s_and_b32 s45, s13, 0xffff
  s_mov_b32 s46, 0x00400000
  s_mov_b32 s47, 0x20000
  v_lshrrev_b32 v4, 3, v2
  v_lshlrev_b32 v4, 3, v4
  v_lshl_add_u32 v4, v1, 4, v4
  v_lshlrev_b32 v4, 10, v4
  v_and_b32 v61, 7, v2
  v_lshl_add_u32 v4, v61, 4, v4
  s_lshl_b32 s55, s32, 19
  s_lshl_b32 s56, s36, 17
  s_add_u32 s55, s55, s56
  s_xor_b32 s56, s35, 4
  s_lshl_b32 s56, s56, 7
  s_add_u32 s55, s55, s56
  s_add_u32 s56, s55, 0
  buffer_load_dwordx4 v[64:67], v4, s[44:47], s56 offen offset:0
  buffer_load_dwordx4 v[68:71], v4, s[44:47], s56 offen offset:1024
  buffer_load_dwordx4 v[72:75], v4, s[44:47], s56 offen offset:2048
  s_waitcnt vmcnt(2)
  buffer_load_dwordx4 v[76:79], v4, s[44:47], s56 offen offset:3072
  s_add_u32 s56, s55, 4096
  s_waitcnt vmcnt(2)
  buffer_load_dwordx4 v[80:83], v4, s[44:47], s56 offen offset:0
  s_waitcnt vmcnt(2)
  buffer_load_dwordx4 v[84:87], v4, s[44:47], s56 offen offset:1024
  s_waitcnt vmcnt(2)
  buffer_load_dwordx4 v[88:91], v4, s[44:47], s56 offen offset:2048
  s_waitcnt vmcnt(2)
  buffer_load_dwordx4 v[92:95], v4, s[44:47], s56 offen offset:3072
  s_add_u32 s56, s55, 65536
  s_waitcnt vmcnt(2)
  buffer_load_dwordx4 v[96:99], v4, s[44:47], s56 offen offset:0
  s_waitcnt vmcnt(2)
  buffer_load_dwordx4 v[100:103], v4, s[44:47], s56 offen offset:1024
  s_waitcnt vmcnt(2)
  buffer_load_dwordx4 v[104:107], v4, s[44:47], s56 offen offset:2048
  s_waitcnt vmcnt(2)
  buffer_load_dwordx4 v[108:111], v4, s[44:47], s56 offen offset:3072
  s_add_u32 s56, s55, 69632
  s_waitcnt vmcnt(2)
  buffer_load_dwordx4 v[112:115], v4, s[44:47], s56 offen offset:0
  s_waitcnt vmcnt(2)
  buffer_load_dwordx4 v[116:119], v4, s[44:47], s56 offen offset:1024
  s_waitcnt vmcnt(2)
  buffer_load_dwordx4 v[120:123], v4, s[44:47], s56 offen offset:2048
  s_waitcnt vmcnt(2)
  buffer_load_dwordx4 v[124:127], v4, s[44:47], s56 offen offset:3072
  s_waitcnt vmcnt(8)
  v_perm_b32 v128, v68, v64, s38
  v_perm_b32 v129, v76, v72, s38
  v_perm_b32 v130, v84, v80, s38
  v_perm_b32 v131, v92, v88, s38
  v_perm_b32 v132, v68, v64, s39
  v_perm_b32 v133, v76, v72, s39
  v_perm_b32 v134, v84, v80, s39
  v_perm_b32 v135, v92, v88, s39
  v_perm_b32 v136, v69, v65, s38
  v_perm_b32 v137, v77, v73, s38
  v_perm_b32 v138, v85, v81, s38
  v_perm_b32 v139, v93, v89, s38
  v_perm_b32 v140, v69, v65, s39
  v_perm_b32 v141, v77, v73, s39
  v_perm_b32 v142, v85, v81, s39
  v_perm_b32 v143, v93, v89, s39
  v_perm_b32 v144, v70, v66, s38
  v_perm_b32 v145, v78, v74, s38
  v_perm_b32 v146, v86, v82, s38
  v_perm_b32 v147, v94, v90, s38
  v_perm_b32 v148, v70, v66, s39
  v_perm_b32 v149, v78, v74, s39
  v_perm_b32 v150, v86, v82, s39
  v_perm_b32 v151, v94, v90, s39
  v_perm_b32 v152, v71, v67, s38
  v_perm_b32 v153, v79, v75, s38
  v_perm_b32 v154, v87, v83, s38
  v_perm_b32 v155, v95, v91, s38
  v_perm_b32 v156, v71, v67, s39
  v_perm_b32 v157, v79, v75, s39
  v_perm_b32 v158, v87, v83, s39
  v_perm_b32 v159, v95, v91, s39
  s_cmp_ge_u32 s36, 2
  s_cselect_b32 s44, s18, s16
  s_cselect_b32 s45, s19, s17
  s_and_b32 s45, s45, 0xffff
  s_mov_b32 s46, 1835008
  s_mov_b32 s47, 0x20000
  s_mov_b32 s48, s20
  s_and_b32 s49, s21, 0xffff
  s_mov_b32 s50, 0x001c0000
  s_mov_b32 s51, 0x20000
  v_lshrrev_b32 v61, 2, v2
  v_lshlrev_b32 v61, 3, v61
  v_lshl_add_u32 v61, v1, 5, v61
  v_mul_u32_u24 v61, 3584, v61
  v_and_b32 v5, 3, v2
  v_lshl_add_u32 v61, v5, 4, v61
  s_and_b32 s61, s36, 1
  s_mul_i32 s61, s61, 917504
  s_lshl_b32 s56, s59, 6
  s_add_u32 s61, s61, s56
  v_lshlrev_b32 v62, 13, v1
  v_lshl_add_u32 v62, v2, 4, v62
  s_lshl_b32 s57, s59, 15
  s_lshl_b32 s56, s36, 8
  s_add_u32 s57, s57, s56
  s_waitcnt vmcnt(0)
  v_perm_b32 v160, v100, v96, s38
  v_perm_b32 v161, v108, v104, s38
  v_perm_b32 v162, v116, v112, s38
  v_perm_b32 v163, v124, v120, s38
  v_perm_b32 v164, v100, v96, s39
  v_perm_b32 v165, v108, v104, s39
  v_perm_b32 v166, v116, v112, s39
  v_perm_b32 v167, v124, v120, s39
  v_perm_b32 v168, v101, v97, s38
  v_perm_b32 v169, v109, v105, s38
  v_perm_b32 v170, v117, v113, s38
  v_perm_b32 v171, v125, v121, s38
  v_perm_b32 v172, v101, v97, s39
  v_perm_b32 v173, v109, v105, s39
  v_perm_b32 v174, v117, v113, s39
  v_perm_b32 v175, v125, v121, s39
  v_perm_b32 v176, v102, v98, s38
  v_perm_b32 v177, v110, v106, s38
  v_perm_b32 v178, v118, v114, s38
  v_perm_b32 v179, v126, v122, s38
  v_perm_b32 v180, v102, v98, s39
  v_perm_b32 v181, v110, v106, s39
  v_perm_b32 v182, v118, v114, s39
  v_perm_b32 v183, v126, v122, s39
  v_perm_b32 v184, v103, v99, s38
  v_perm_b32 v185, v111, v107, s38
  v_perm_b32 v186, v119, v115, s38
  v_perm_b32 v187, v127, v123, s38
  v_perm_b32 v188, v103, v99, s39
  v_perm_b32 v189, v111, v107, s39
  v_perm_b32 v190, v119, v115, s39
  v_perm_b32 v191, v127, v123, s39
  s_and_b32 s55, s59, 6
  s_cmp_eq_u32 s55, 6
  s_cbranch_scc1 L_slow_18
  s_add_u32 s56, s61, 0
  s_waitcnt vmcnt(2)
  buffer_load_dwordx4 v[192:195], v61, s[44:47], s56 offen offset:0
  s_waitcnt vmcnt(2)
  buffer_load_dwordx4 v[196:199], v61, s[44:47], s56 offen offset:3584
  s_add_u32 s56, s61, 7168
  s_waitcnt vmcnt(2)
  buffer_load_dwordx4 v[200:203], v61, s[44:47], s56 offen offset:0
  s_waitcnt vmcnt(2)
  buffer_load_dwordx4 v[204:207], v61, s[44:47], s56 offen offset:3584
  s_add_u32 s56, s61, 14336
  s_waitcnt vmcnt(2)
  buffer_load_dwordx4 v[208:211], v61, s[44:47], s56 offen offset:0
  s_waitcnt vmcnt(2)
  buffer_load_dwordx4 v[212:215], v61, s[44:47], s56 offen offset:3584
  s_add_u32 s56, s61, 21504
  s_waitcnt vmcnt(2)
  buffer_load_dwordx4 v[216:219], v61, s[44:47], s56 offen offset:0
  s_waitcnt vmcnt(2)
  buffer_load_dwordx4 v[220:223], v61, s[44:47], s56 offen offset:3584
L_slow_18:
  s_add_u32 s56, s61, 458752
  s_waitcnt vmcnt(2)
  buffer_load_dwordx4 v[224:227], v61, s[44:47], s56 offen offset:0
  s_waitcnt vmcnt(2)
  buffer_load_dwordx4 v[228:231], v61, s[44:47], s56 offen offset:3584
  s_add_u32 s56, s61, 465920
  s_waitcnt vmcnt(2)
  buffer_load_dwordx4 v[232:235], v61, s[44:47], s56 offen offset:0
  s_waitcnt vmcnt(2)
  buffer_load_dwordx4 v[236:239], v61, s[44:47], s56 offen offset:3584
  s_add_u32 s56, s61, 473088
  s_waitcnt vmcnt(2)
  buffer_load_dwordx4 v[240:243], v61, s[44:47], s56 offen offset:0
  s_waitcnt vmcnt(2)
  buffer_load_dwordx4 v[244:247], v61, s[44:47], s56 offen offset:3584
  s_add_u32 s56, s61, 480256
  s_waitcnt vmcnt(2)
  buffer_load_dwordx4 v[248:251], v61, s[44:47], s56 offen offset:0
  s_waitcnt vmcnt(2)
  buffer_load_dwordx4 v[252:255], v61, s[44:47], s56 offen offset:3584
L_slow_19:
  s_branch L_wdone
L_w_final:
  s_mov_b32 s44, s12
  s_and_b32 s45, s13, 0xffff
  s_mov_b32 s46, 0x00400000
  s_mov_b32 s47, 0x20000
  v_lshrrev_b32 v4, 3, v2
  v_lshlrev_b32 v4, 3, v4
  v_lshl_add_u32 v4, v1, 4, v4
  v_lshlrev_b32 v4, 10, v4
  v_and_b32 v61, 7, v2
  v_lshl_add_u32 v4, v61, 4, v4
  s_lshl_b32 s55, s32, 19
  s_lshl_b32 s56, s36, 17
  s_add_u32 s55, s55, s56
  s_xor_b32 s56, s35, 4
  s_lshl_b32 s56, s56, 7
  s_add_u32 s55, s55, s56
  s_add_u32 s56, s55, 0
  buffer_load_dwordx4 v[64:67], v4, s[44:47], s56 offen offset:0
  buffer_load_dwordx4 v[68:71], v4, s[44:47], s56 offen offset:1024
  buffer_load_dwordx4 v[72:75], v4, s[44:47], s56 offen offset:2048
  s_waitcnt vmcnt(2)
  buffer_load_dwordx4 v[76:79], v4, s[44:47], s56 offen offset:3072
  s_add_u32 s56, s55, 4096
  s_waitcnt vmcnt(2)
  buffer_load_dwordx4 v[80:83], v4, s[44:47], s56 offen offset:0
  s_waitcnt vmcnt(2)
  buffer_load_dwordx4 v[84:87], v4, s[44:47], s56 offen offset:1024
  s_waitcnt vmcnt(2)
  buffer_load_dwordx4 v[88:91], v4, s[44:47], s56 offen offset:2048
  s_waitcnt vmcnt(2)
  buffer_load_dwordx4 v[92:95], v4, s[44:47], s56 offen offset:3072
  s_add_u32 s56, s55, 65536
  s_waitcnt vmcnt(2)
  buffer_load_dwordx4 v[96:99], v4, s[44:47], s56 offen offset:0
  s_waitcnt vmcnt(2)
  buffer_load_dwordx4 v[100:103], v4, s[44:47], s56 offen offset:1024
  s_waitcnt vmcnt(2)
  buffer_load_dwordx4 v[104:107], v4, s[44:47], s56 offen offset:2048
  s_waitcnt vmcnt(2)
  buffer_load_dwordx4 v[108:111], v4, s[44:47], s56 offen offset:3072
  s_add_u32 s56, s55, 69632
  s_waitcnt vmcnt(2)
  buffer_load_dwordx4 v[112:115], v4, s[44:47], s56 offen offset:0
  s_waitcnt vmcnt(2)
  buffer_load_dwordx4 v[116:119], v4, s[44:47], s56 offen offset:1024
  s_waitcnt vmcnt(2)
  buffer_load_dwordx4 v[120:123], v4, s[44:47], s56 offen offset:2048
  s_waitcnt vmcnt(2)
  buffer_load_dwordx4 v[124:127], v4, s[44:47], s56 offen offset:3072
  s_waitcnt vmcnt(8)
  v_perm_b32 v128, v68, v64, s38
  v_perm_b32 v129, v76, v72, s38
  v_perm_b32 v130, v84, v80, s38
  v_perm_b32 v131, v92, v88, s38
  v_perm_b32 v132, v68, v64, s39
  v_perm_b32 v133, v76, v72, s39
  v_perm_b32 v134, v84, v80, s39
  v_perm_b32 v135, v92, v88, s39
  v_perm_b32 v136, v69, v65, s38
  v_perm_b32 v137, v77, v73, s38
  v_perm_b32 v138, v85, v81, s38
  v_perm_b32 v139, v93, v89, s38
  v_perm_b32 v140, v69, v65, s39
  v_perm_b32 v141, v77, v73, s39
  v_perm_b32 v142, v85, v81, s39
  v_perm_b32 v143, v93, v89, s39
  v_perm_b32 v144, v70, v66, s38
  v_perm_b32 v145, v78, v74, s38
  v_perm_b32 v146, v86, v82, s38
  v_perm_b32 v147, v94, v90, s38
  v_perm_b32 v148, v70, v66, s39
  v_perm_b32 v149, v78, v74, s39
  v_perm_b32 v150, v86, v82, s39
  v_perm_b32 v151, v94, v90, s39
  v_perm_b32 v152, v71, v67, s38
  v_perm_b32 v153, v79, v75, s38
  v_perm_b32 v154, v87, v83, s38
  v_perm_b32 v155, v95, v91, s38
  v_perm_b32 v156, v71, v67, s39
  v_perm_b32 v157, v79, v75, s39
  v_perm_b32 v158, v87, v83, s39
  v_perm_b32 v159, v95, v91, s39
  s_waitcnt vmcnt(0)
  v_perm_b32 v160, v100, v96, s38
  v_perm_b32 v161, v108, v104, s38
  v_perm_b32 v162, v116, v112, s38
  v_perm_b32 v163, v124, v120, s38
  v_perm_b32 v164, v100, v96, s39
  v_perm_b32 v165, v108, v104, s39
  v_perm_b32 v166, v116, v112, s39
  v_perm_b32 v167, v124, v120, s39
  v_perm_b32 v168, v101, v97, s38
  v_perm_b32 v169, v109, v105, s38
  v_perm_b32 v170, v117, v113, s38
  v_perm_b32 v171, v125, v121, s38
  v_perm_b32 v172, v101, v97, s39
  v_perm_b32 v173, v109, v105, s39
  v_perm_b32 v174, v117, v113, s39
  v_perm_b32 v175, v125, v121, s39
  v_perm_b32 v176, v102, v98, s38
  v_perm_b32 v177, v110, v106, s38
  v_perm_b32 v178, v118, v114, s38
  v_perm_b32 v179, v126, v122, s38
  v_perm_b32 v180, v102, v98, s39
  v_perm_b32 v181, v110, v106, s39
  v_perm_b32 v182, v118, v114, s39
  v_perm_b32 v183, v126, v122, s39
  v_perm_b32 v184, v103, v99, s38
  v_perm_b32 v185, v111, v107, s38
  v_perm_b32 v186, v119, v115, s38
  v_perm_b32 v187, v127, v123, s38
  v_perm_b32 v188, v103, v99, s39
  v_perm_b32 v189, v111, v107, s39
  v_perm_b32 v190, v119, v115, s39
  v_perm_b32 v191, v127, v123, s39
  s_branch L_wdone
L_midB:
  s_cmp_eq_u32 s35, 7
  s_cbranch_scc1 L_w_finalB
  s_mul_i32 s59, s32, 7
  s_add_u32 s59, s59, s35
  s_waitcnt vmcnt(0)
  v_perm_b32 v128, v68, v64, s38
  v_perm_b32 v129, v76, v72, s38
  v_perm_b32 v130, v84, v80, s38
  v_perm_b32 v131, v92, v88, s38
  v_perm_b32 v132, v68, v64, s39
  v_perm_b32 v133, v76, v72, s39
  v_perm_b32 v134, v84, v80, s39
  v_perm_b32 v135, v92, v88, s39
  v_perm_b32 v136, v69, v65, s38
  v_perm_b32 v137, v77, v73, s38
  v_perm_b32 v138, v85, v81, s38
  v_perm_b32 v139, v93, v89, s38
  v_perm_b32 v140, v69, v65, s39
  v_perm_b32 v141, v77, v73, s39
  v_perm_b32 v142, v85, v81, s39
  v_perm_b32 v143, v93, v89, s39
  v_perm_b32 v144, v70, v66, s38
  v_perm_b32 v145, v78, v74, s38
  v_perm_b32 v146, v86, v82, s38
  v_perm_b32 v147, v94, v90, s38
  v_perm_b32 v148, v70, v66, s39
  v_perm_b32 v149, v78, v74, s39
  v_perm_b32 v150, v86, v82, s39
  v_perm_b32 v151, v94, v90, s39
  v_perm_b32 v152, v71, v67, s38
  v_perm_b32 v153, v79, v75, s38
  v_perm_b32 v154, v87, v83, s38
  v_perm_b32 v155, v95, v91, s38
  v_perm_b32 v156, v71, v67, s39
  v_perm_b32 v157, v79, v75, s39
  v_perm_b32 v158, v87, v83, s39
  v_perm_b32 v159, v95, v91, s39
  s_cmp_ge_u32 s36, 2
  s_cselect_b32 s44, s18, s16
  s_cselect_b32 s45, s19, s17
  s_and_b32 s45, s45, 0xffff
  s_mov_b32 s46, 1835008
  s_mov_b32 s47, 0x20000
  s_mov_b32 s48, s20
  s_and_b32 s49, s21, 0xffff
  s_mov_b32 s50, 0x001c0000
  s_mov_b32 s51, 0x20000
  v_lshrrev_b32 v61, 2, v2
  v_lshlrev_b32 v61, 3, v61
  v_lshl_add_u32 v61, v1, 5, v61
  v_mul_u32_u24 v61, 3584, v61
  v_and_b32 v5, 3, v2
  v_lshl_add_u32 v61, v5, 4, v61
  s_and_b32 s61, s36, 1
  s_mul_i32 s61, s61, 917504
  s_lshl_b32 s56, s59, 6
  s_add_u32 s61, s61, s56
  v_lshlrev_b32 v62, 13, v1
  v_lshl_add_u32 v62, v2, 4, v62
  s_lshl_b32 s57, s59, 15
  s_lshl_b32 s56, s36, 8
  s_add_u32 s57, s57, s56
  s_waitcnt vmcnt(0)
  v_perm_b32 v160, v100, v96, s38
  v_perm_b32 v161, v108, v104, s38
  v_perm_b32 v162, v116, v112, s38
  v_perm_b32 v163, v124, v120, s38
  v_perm_b32 v164, v100, v96, s39
  v_perm_b32 v165, v108, v104, s39
  v_perm_b32 v166, v116, v112, s39
  v_perm_b32 v167, v124, v120, s39
  v_perm_b32 v168, v101, v97, s38
  v_perm_b32 v169, v109, v105, s38
  v_perm_b32 v170, v117, v113, s38
  v_perm_b32 v171, v125, v121, s38
  v_perm_b32 v172, v101, v97, s39
  v_perm_b32 v173, v109, v105, s39
  v_perm_b32 v174, v117, v113, s39
  v_perm_b32 v175, v125, v121, s39
  v_perm_b32 v176, v102, v98, s38
  v_perm_b32 v177, v110, v106, s38
  v_perm_b32 v178, v118, v114, s38
  v_perm_b32 v179, v126, v122, s38
  v_perm_b32 v180, v102, v98, s39
  v_perm_b32 v181, v110, v106, s39
  v_perm_b32 v182, v118, v114, s39
  v_perm_b32 v183, v126, v122, s39
  v_perm_b32 v184, v103, v99, s38
  v_perm_b32 v185, v111, v107, s38
  v_perm_b32 v186, v119, v115, s38
  v_perm_b32 v187, v127, v123, s38
  v_perm_b32 v188, v103, v99, s39
  v_perm_b32 v189, v111, v107, s39
  v_perm_b32 v190, v119, v115, s39
  v_perm_b32 v191, v127, v123, s39
  s_and_b32 s55, s59, 6
  s_cmp_eq_u32 s55, 6
  s_cbranch_scc1 L_slow_20
  s_add_u32 s56, s61, 0
  s_waitcnt vmcnt(3)
  buffer_load_dwordx4 v[192:195], v61, s[44:47], s56 offen offset:0
  s_waitcnt vmcnt(3)
  buffer_load_dwordx4 v[196:199], v61, s[44:47], s56 offen offset:3584
  s_add_u32 s56, s61, 7168
  s_waitcnt vmcnt(3)
  buffer_load_dwordx4 v[200:203], v61, s[44:47], s56 offen offset:0
  s_waitcnt vmcnt(3)
  buffer_load_dwordx4 v[204:207], v61, s[44:47], s56 offen offset:3584
  s_add_u32 s56, s61, 14336
  s_waitcnt vmcnt(3)
  buffer_load_dwordx4 v[208:211], v61, s[44:47], s56 offen offset:0
  s_waitcnt vmcnt(3)
  buffer_load_dwordx4 v[212:215], v61, s[44:47], s56 offen offset:3584
  s_add_u32 s56, s61, 21504
  s_waitcnt vmcnt(3)
  buffer_load_dwordx4 v[216:219], v61, s[44:47], s56 offen offset:0
  s_waitcnt vmcnt(3)
  buffer_load_dwordx4 v[220:223], v61, s[44:47], s56 offen offset:3584
L_slow_20:
  s_add_u32 s56, s61, 458752
  s_waitcnt vmcnt(3)
  buffer_load_dwordx4 v[224:227], v61, s[44:47], s56 offen offset:0
  s_waitcnt vmcnt(3)
  buffer_load_dwordx4 v[228:231], v61, s[44:47], s56 offen offset:3584
  s_add_u32 s56, s61, 465920
  s_waitcnt vmcnt(3)
  buffer_load_dwordx4 v[232:235], v61, s[44:47], s56 offen offset:0
  s_waitcnt vmcnt(3)
  buffer_load_dwordx4 v[236:239], v61, s[44:47], s56 offen offset:3584
  s_add_u32 s56, s61, 473088
  s_waitcnt vmcnt(3)
  buffer_load_dwordx4 v[240:243], v61, s[44:47], s56 offen offset:0
  s_waitcnt vmcnt(3)
  buffer_load_dwordx4 v[244:247], v61, s[44:47], s56 offen offset:3584
  s_add_u32 s56, s61, 480256
  s_waitcnt vmcnt(3)
  buffer_load_dwordx4 v[248:251], v61, s[44:47], s56 offen offset:0
  s_waitcnt vmcnt(3)
  buffer_load_dwordx4 v[252:255], v61, s[44:47], s56 offen offset:3584
L_slow_21:
  s_branch L_wdone
L_w_finalB:
  s_waitcnt vmcnt(0)
  v_perm_b32 v128, v68, v64, s38
  v_perm_b32 v129, v76, v72, s38
  v_perm_b32 v130, v84, v80, s38
  v_perm_b32 v131, v92, v88, s38
  v_perm_b32 v132, v68, v64, s39
  v_perm_b32 v133, v76, v72, s39
  v_perm_b32 v134, v84, v80, s39
  v_perm_b32 v135, v92, v88, s39
  v_perm_b32 v136, v69, v65, s38
  v_perm_b32 v137, v77, v73, s38
  v_perm_b32 v138, v85, v81, s38
  v_perm_b32 v139, v93, v89, s38
  v_perm_b32 v140, v69, v65, s39
  v_perm_b32 v141, v77, v73, s39
  v_perm_b32 v142, v85, v81, s39
  v_perm_b32 v143, v93, v89, s39
  v_perm_b32 v144, v70, v66, s38
  v_perm_b32 v145, v78, v74, s38
  v_perm_b32 v146, v86, v82, s38
  v_perm_b32 v147, v94, v90, s38
  v_perm_b32 v148, v70, v66, s39
  v_perm_b32 v149, v78, v74, s39
  v_perm_b32 v150, v86, v82, s39
  v_perm_b32 v151, v94, v90, s39
  v_perm_b32 v152, v71, v67, s38
  v_perm_b32 v153, v79, v75, s38
  v_perm_b32 v154, v87, v83, s38
  v_perm_b32 v155, v95, v91, s38
  v_perm_b32 v156, v71, v67, s39
  v_perm_b32 v157, v79, v75, s39
  v_perm_b32 v158, v87, v83, s39
  v_perm_b32 v159, v95, v91, s39
  s_waitcnt vmcnt(0)
  v_perm_b32 v160, v100, v96, s38
  v_perm_b32 v161, v108, v104, s38
  v_perm_b32 v162, v116, v112, s38
  v_perm_b32 v163, v124, v120, s38
  v_perm_b32 v164, v100, v96, s39
  v_perm_b32 v165, v108, v104, s39
  v_perm_b32 v166, v116, v112, s39
  v_perm_b32 v167, v124, v120, s39
  v_perm_b32 v168, v101, v97, s38
  v_perm_b32 v169, v109, v105, s38
  v_perm_b32 v170, v117, v113, s38
  v_perm_b32 v171, v125, v121, s38
  v_perm_b32 v172, v101, v97, s39
  v_perm_b32 v173, v109, v105, s39
  v_perm_b32 v174, v117, v113, s39
  v_perm_b32 v175, v125, v121, s39
  v_perm_b32 v176, v102, v98, s38
  v_perm_b32 v177, v110, v106, s38
  v_perm_b32 v178, v118, v114, s38
  v_perm_b32 v179, v126, v122, s38
  v_perm_b32 v180, v102, v98, s39
  v_perm_b32 v181, v110, v106, s39
  v_perm_b32 v182, v118, v114, s39
  v_perm_b32 v183, v126, v122, s39
  v_perm_b32 v184, v103, v99, s38
  v_perm_b32 v185, v111, v107, s38
  v_perm_b32 v186, v119, v115, s38
  v_perm_b32 v187, v127, v123, s38
  v_perm_b32 v188, v103, v99, s39
  v_perm_b32 v189, v111, v107, s39
  v_perm_b32 v190, v119, v115, s39
  v_perm_b32 v191, v127, v123, s39
L_wdone:
  s_cmp_eq_u32 s35, 7
  s_cbranch_scc0 L_nar_22
  s_cmp_eq_u32 s36, 3
  s_cbranch_scc0 L_nar_22
  s_add_u32 s62, s54, 16
  s_lshl_b32 s55, s62, 13
  s_add_u32 s55, s55, 1572864
  s_add_u32 s58, s55, 4096
  v_lshlrev_b32 v3, 4, v0
  v_mul_u32_u24 v5, 12288, v1
  v_lshl_add_u32 v5, v2, 4, v5
  s_lshl_b32 s60, s62, 8
  s_add_u32 s60, s60, 8192
  s_mov_b32 s52, 1
  s_branch L_ared_23_go
L_ared_23:
  s_add_u32 s52, s52, 1
  s_cmp_gt_u32 s52, 400000
  s_cbranch_scc1 L_end
L_ared_23_go:
  buffer_load_dwordx4 v[16:19], v3, s[40:43], s55 offen offset:0 sc1
  buffer_load_dwordx4 v[20:23], v3, s[40:43], s55 offen offset:1024 sc1
  buffer_load_dwordx4 v[24:27], v3, s[40:43], s55 offen offset:2048 sc1
  buffer_load_dwordx4 v[28:31], v3, s[40:43], s55 offen offset:3072 sc1
  buffer_load_dwordx4 v[32:35], v3, s[40:43], s58 offen offset:0 sc1
  buffer_load_dwordx4 v[36:39], v3, s[40:43], s58 offen offset:1024 sc1
  buffer_load_dwordx4 v[40:43], v3, s[40:43], s58 offen offset:2048 sc1
  buffer_load_dwordx4 v[44:47], v3, s[40:43], s58 offen offset:3072 sc1
  s_waitcnt vmcnt(0)
  v_xor_b32 v16, s94, v16
  v_xor_b32 v17, s95, v17
  v_xor_b32 v18, s96, v18
  v_xor_b32 v19, s97, v19
  v_xor_b32 v20, s94, v20
  v_xor_b32 v21, s95, v21
  v_xor_b32 v22, s96, v22
  v_xor_b32 v23, s97, v23
  v_xor_b32 v24, s94, v24
  v_xor_b32 v25, s95, v25
  v_xor_b32 v26, s96, v26
  v_xor_b32 v27, s97, v27
  v_xor_b32 v28, s94, v28
  v_xor_b32 v29, s95, v29
  v_xor_b32 v30, s96, v30
  v_xor_b32 v31, s97, v31
  v_xor_b32 v32, s94, v32
  v_xor_b32 v33, s95, v33
  v_xor_b32 v34, s96, v34
  v_xor_b32 v35, s97, v35
  v_xor_b32 v36, s94, v36
  v_xor_b32 v37, s95, v37
  v_xor_b32 v38, s96, v38
  v_xor_b32 v39, s97, v39
  v_xor_b32 v40, s94, v40
  v_xor_b32 v41, s95, v41
  v_xor_b32 v42, s96, v42
  v_xor_b32 v43, s97, v43
  v_xor_b32 v44, s94, v44
  v_xor_b32 v45, s95, v45
  v_xor_b32 v46, s96, v46
  v_xor_b32 v47, s97, v47
  v_or3_b32 v6, v16, v18, v20
  v_or3_b32 v7, v17, v19, v21
  v_or3_b32 v6, v6, v22, v24
  v_or3_b32 v7, v7, v23, v25
  v_or3_b32 v6, v6, v26, v28
  v_or3_b32 v7, v7, v27, v29
  v_or3_b32 v6, v6, v30, v32
  v_or3_b32 v7, v7, v31, v33
  v_or3_b32 v6, v6, v34, v36
  v_or3_b32 v7, v7, v35, v37
  v_or3_b32 v6, v6, v38, v40
  v_or3_b32 v7, v7, v39, v41
  v_or3_b32 v6, v6, v42, v44
  v_or3_b32 v7, v7, v43, v45
  v_or_b32 v6, v6, v46
  v_or_b32 v7, v7, v47
  v_or_b32 v6, v6, v7
  v_and_b32 v6, 0xff, v6
  v_cmp_ne_u32 vcc, 0, v6
  s_cbranch_vccnz L_ared_23
  v_pk_add_f32 v[16:17], v[16:17], v[20:21]
  v_pk_add_f32 v[18:19], v[18:19], v[22:23]
  v_pk_add_f32 v[24:25], v[24:25], v[28:29]
  v_pk_add_f32 v[26:27], v[26:27], v[30:31]
  v_pk_add_f32 v[32:33], v[32:33], v[36:37]
  v_pk_add_f32 v[34:35], v[34:35], v[38:39]
  v_pk_add_f32 v[40:41], v[40:41], v[44:45]
  v_pk_add_f32 v[42:43], v[42:43], v[46:47]
  v_pk_add_f32 v[16:17], v[16:17], v[24:25]
  v_pk_add_f32 v[18:19], v[18:19], v[26:27]
  v_pk_add_f32 v[32:33], v[32:33], v[40:41]
  v_pk_add_f32 v[34:35], v[34:35], v[42:43]
  v_pk_add_f32 v[16:17], v[16:17], v[32:33]
  v_pk_add_f32 v[18:19], v[18:19], v[34:35]
  v_cvt_pk_bf16_f32 v16, v16, v17
  v_cvt_pk_bf16_f32 v18, v18, v19
  v_mov_b32 v17, s37
  v_mov_b32 v19, s37
  buffer_store_dwordx4 v[16:19], v5, s[40:43], s60 offen sc1
L_nar_22:
  s_mul_i32 s60, s34, 12288
  s_add_u32 s60, s60, 8192
  s_cmp_eq_u32 s35, 7
  s_cbranch_scc1 L_mid_final
  s_lshl_b32 s55, s36, 8
  s_lshl_b32 s56, s34, 10
  s_add_u32 s55, s55, s56
  v_lshl_add_u32 v3, v0, 2, s55
  v_mov_b32 v4, s56
  global_load_dword v24, v3, s[4:5]
  global_load_dword v25, v4, s[4:5]
  s_lshl_b32 s55, s36, 9
  s_add_u32 s55, s55, s60
  v_lshlrev_b32 v3, 3, v0
  s_add_u32 s56, s55, 4096
  s_add_u32 s58, s55, 8192
  s_mov_b32 s52, 1
  s_branch L_gpoll_24_go
L_gpoll_24:
  s_add_u32 s52, s52, 1
  s_cmp_gt_u32 s52, 400000
  s_cbranch_scc1 L_end
L_gpoll_24_go:
  buffer_load_dwordx2 v[26:27], v3, s[40:43], s56 offen sc1
  buffer_load_dwordx2 v[28:29], v3, s[40:43], s56 offen offset:2048 sc1
  buffer_load_dwordx2 v[30:31], v3, s[40:43], s58 offen sc1
  s_waitcnt vmcnt(0)
  v_xor_b32 v4, s37, v27
  v_xor_b32 v5, s37, v29
  v_or_b32 v4, v4, v5
  v_xor_b32 v5, s37, v31
  v_or_b32 v4, v4, v5
  v_cmp_ne_u32 vcc, 0, v4
  s_cbranch_vccnz L_gpoll_24
  v_lshlrev_b32 v16, 16, v24
  v_and_b32 v17, 0xffff0000, v24
  v_lshlrev_b32 v18, 16, v26
  v_and_b32 v19, 0xffff0000, v26
  v_lshlrev_b32 v20, 16, v28
  v_and_b32 v21, 0xffff0000, v28
  v_lshlrev_b32 v22, 16, v30
  v_and_b32 v23, 0xffff0000, v30
  v_add_f32 v22, 1.0, v22
  v_add_f32 v23, 1.0, v23
  v_lshlrev_b32 v15, 16, v25
  v_cvt_pk_bf16_f32 v4, v22, v23
  v_lshlrev_b32 v22, 16, v4
  v_and_b32 v23, 0xffff0000, v4
  s_branch L_bar2
L_mid_final:
  s_and_b32 s55, s32, 1
  s_lshl_b32 s55, s55, 3
  s_lshr_b32 s56, s36, 1
  s_lshl_b32 s56, s56, 2
  s_add_u32 s62, s55, s56
  s_lshr_b32 s55, s32, 1
  s_lshl_b32 s55, s55, 7
  s_lshl_b32 s56, s62, 3
  s_add_u32 s55, s55, s56
  s_and_b32 s56, s36, 1
  s_lshl_b32 s56, s56, 2
  s_add_u32 s55, s55, s56
  v_and_b32 v6, 3, v0
  v_lshlrev_b32 v7, 3, v6
  v_add_u32 v7, s55, v7
  s_lshl_b32 s55, s34, 10
  v_lshl_add_u32 v3, v7, 1, s55
  global_load_dwordx2 v[24:25], v3, s[4:5]
  v_lshlrev_b32 v3, 2, v7
  s_add_u32 s56, s60, 4096
  s_add_u32 s58, s60, 10240
  s_mov_b32 s52, 1
  s_branch L_fpoll_25_go
L_fpoll_25:
  s_add_u32 s52, s52, 1
  s_cmp_gt_u32 s52, 400000
  s_cbranch_scc1 L_end
L_fpoll_25_go:
  buffer_load_dwordx4 v[28:31], v3, s[40:43], s56 offen sc1
  buffer_load_dwordx4 v[32:35], v3, s[40:43], s58 offen sc1
  s_waitcnt vmcnt(0)
  v_xor_b32 v4, s37, v29
  v_xor_b32 v5, s37, v31
  v_or_b32 v4, v4, v5
  v_xor_b32 v5, s37, v33
  v_or_b32 v4, v4, v5
  v_xor_b32 v5, s37, v35
  v_or_b32 v4, v4, v5
  v_cmp_ne_u32 vcc, 0, v4
  s_cbranch_vccnz L_fpoll_25
  v_lshlrev_b32 v16, 16, v24
  v_and_b32 v17, 0xffff0000, v24
  v_lshlrev_b32 v18, 16, v25
  v_and_b32 v19, 0xffff0000, v25
  v_lshlrev_b32 v20, 16, v28
  v_and_b32 v21, 0xffff0000, v28
  v_lshlrev_b32 v22, 16, v30
  v_and_b32 v23, 0xffff0000, v30
  v_lshlrev_b32 v12, 16, v32
  v_and_b32 v13, 0xffff0000, v32
  v_lshlrev_b32 v14, 16, v34
  v_and_b32 v15, 0xffff0000, v34
  v_cmp_eq_u32 vcc, 1, v1
  v_cmp_eq_u32 s[56:57], 2, v1
  v_cmp_eq_u32 s[58:59], 3, v1
  v_cndmask_b32 v16, v16, v17, vcc
  v_cndmask_b32 v16, v16, v18, s[56:57]
  v_cndmask_b32 v16, v16, v19, s[58:59]
  v_cndmask_b32 v20, v20, v21, vcc
  v_cndmask_b32 v20, v20, v22, s[56:57]
  v_cndmask_b32 v20, v20, v23, s[58:59]
  v_cndmask_b32 v12, v12, v13, vcc
  v_cndmask_b32 v12, v12, v14, s[56:57]
  v_cndmask_b32 v12, v12, v15, s[58:59]
L_bar2:
  v_and_b32 v3, 31, v0
  v_lshrrev_b32 v4, 5, v0
  v_mul_u32_u24 v8, 80, v3
  s_lshl_b32 s55, s36, 4
  s_add_u32 s55, s55, 132096
  v_add_u32 v8, s55, v8
  s_lshl_b32 s55, s36, 3
  s_add_u32 s55, s55, 142336
  v_mov_b32 v9, s55
  s_mul_i32 s60, s54, 17408
  s_add_u32 s60, s60, 327680
  s_lshl_b32 s55, s36, 9
  v_lshlrev_b32 v10, 4, v3
  v_add_u32 v10, s55, v10
  s_lshl_b32 s55, s36, 4
  s_add_u32 s55, s55, 2048
  v_mov_b32 v11, s55
  v_mul_u32_u24 v5, 2176, v4
  v_add_u32 v56, v10, v5
  v_add_u32 v57, v11, v5
  s_mul_i32 s58, s35, 2176
  s_add_u32 s58, s58, s60
  s_lshl_b32 s55, s36, 9
  s_add_u32 s55, s55, 150656
  v_and_b32 v5, 7, v0
  v_lshlrev_b32 v5, 5, v5
  v_lshl_add_u32 v5, v4, 8, v5
  v_add_u32 v60, s55, v5
  v_lshlrev_b32 v58, 4, v0
  v_add_u32 v59, 150656, v58
  s_add_u32 s10, s60, 4352
  s_add_u32 s11, s60, 8704
  s_add_u32 s12, s60, 13056
  s_lshl_b32 s13, s54, 11
  s_xor_b32 s55, s35, 4
  s_lshl_b32 s55, s55, 8
  s_add_u32 s13, s13, s55
  s_add_u32 s13, s13, 917504
  s_lshl_b32 s14, s34, 14
  s_add_u32 s14, s14, 917504
  s_mov_b32 s22, 0
  s_mov_b32 s23, -1
  v_mov_b32 v55, 157888
  s_and_b32 s55, s59, 6
  s_cmp_eq_u32 s55, 6
  s_cselect_b32 s21, 1, 0
  s_cmp_eq_u32 s35, 7
  s_cselect_b32 s21, 0, s21
  s_cmp_eq_u32 s21, 1
  s_cbranch_scc0 L_nsl0_26
  v_mov_b32 v5, 157896
  s_mov_b32 s52, 1
  s_branch L_lw_27_go
L_lw_27:
  s_add_u32 s52, s52, 1
  s_cmp_gt_u32 s52, 400000
  s_cbranch_scc1 L_end
L_lw_27_go:
  ds_read_b32 v6, v5
  s_waitcnt lgkmcnt(0)
  v_readfirstlane_b32 s55, v6
  s_nop 0
  s_cmp_ge_u32 s55, 4
  s_cbranch_scc0 L_lw_27
  s_add_u32 s56, s61, 0
  buffer_load_dwordx4 v[192:195], v61, s[44:47], s56 offen offset:0
  buffer_load_dwordx4 v[196:199], v61, s[44:47], s56 offen offset:3584
  s_add_u32 s56, s61, 7168
  buffer_load_dwordx4 v[200:203], v61, s[44:47], s56 offen offset:0
  buffer_load_dwordx4 v[204:207], v61, s[44:47], s56 offen offset:3584
  s_add_u32 s56, s61, 14336
  buffer_load_dwordx4 v[208:211], v61, s[44:47], s56 offen offset:0
  buffer_load_dwordx4 v[212:215], v61, s[44:47], s56 offen offset:3584
  s_add_u32 s56, s61, 21504
  buffer_load_dwordx4 v[216:219], v61, s[44:47], s56 offen offset:0
  buffer_load_dwordx4 v[220:223], v61, s[44:47], s56 offen offset:3584
L_nsl0_26:
  v_mov_b32 v5, 157892
  s_mov_b32 s52, 1
  s_branch L_lw_28_go
L_lw_28:
  s_add_u32 s52, s52, 1
  s_cmp_gt_u32 s52, 400000
  s_cbranch_scc1 L_end
L_lw_28_go:
  ds_read_b32 v6, v5
  s_waitcnt lgkmcnt(0)
  v_readfirstlane_b32 s55, v6
  s_nop 0
  s_cmp_ge_u32 s55, 4
  s_cbranch_scc0 L_lw_28
  ds_read_b32 v55, v55
  ds_read_b64 v[24:25], v9 offset:0
  ds_read_b64 v[26:27], v9 offset:32
  ds_read_b64 v[28:29], v9 offset:64
  ds_read_b64 v[30:31], v9 offset:96
  s_waitcnt lgkmcnt(0)
  v_readfirstlane_b32 s63, v55
  v_max3_f32 v40, v24, v26, v28
  v_max_f32 v40, v40, v30
  v_and_b32 v40, 0xffffff00, v40
  v_sub_f32 v24, v24, v40
  v_sub_f32 v26, v26, v40
  v_sub_f32 v28, v28, v40
  v_sub_f32 v30, v30, v40
  v_exp_f32 v24, v24
  v_exp_f32 v26, v26
  v_exp_f32 v28, v28
  v_exp_f32 v30, v30
  v_mul_f32 v41, v24, v25
  v_mul_f32 v42, v28, v29
  v_fmac_f32 v41, v26, v27
  v_fmac_f32 v42, v30, v31
  v_add_f32 v41, v41, v42
  v_perm_b32 v40, v40, v63, s98
  v_perm_b32 v41, v41, v63, s99
  v_perm_b32 v42, v41, v63, s100
  v_perm_b32 v43, v41, v63, s101
  s_barrier
  ds_read_b128 v[32:35], v8 offset:0
  ds_read_b128 v[44:47], v8 offset:2560
  ds_read_b128 v[48:51], v8 offset:5120
  ds_read_b128 v[52:55], v8 offset:7680
  s_waitcnt lgkmcnt(3)
  v_pk_mul_f32 v[32:33], v[32:33], v[24:25] op_sel_hi:[1,0]
  v_pk_mul_f32 v[34:35], v[34:35], v[24:25] op_sel_hi:[1,0]
  s_waitcnt lgkmcnt(2)
  v_pk_fma_f32 v[32:33], v[44:45], v[26:27], v[32:33] op_sel_hi:[1,0,1]
  v_pk_fma_f32 v[34:35], v[46:47], v[26:27], v[34:35] op_sel_hi:[1,0,1]
  s_waitcnt lgkmcnt(1)
  v_pk_fma_f32 v[32:33], v[48:49], v[28:29], v[32:33] op_sel_hi:[1,0,1]
  v_pk_fma_f32 v[34:35], v[50:51], v[28:29], v[34:35] op_sel_hi:[1,0,1]
  s_waitcnt lgkmcnt(0)
  v_pk_fma_f32 v[32:33], v[52:53], v[30:31], v[32:33] op_sel_hi:[1,0,1]
  v_pk_fma_f32 v[34:35], v[54:55], v[30:31], v[34:35] op_sel_hi:[1,0,1]
  v_perm_b32 v32, v32, v63, s98
  v_perm_b32 v33, v33, v63, s99
  v_perm_b32 v34, v34, v63, s100
  v_perm_b32 v35, v35, v63, s101
  s_cmp_eq_u32 s63, 2
  s_cbranch_scc0 L_or_29
  s_mov_b32 exec_lo, -1
  s_mov_b32 exec_hi, 0
  buffer_store_dwordx4 v[32:35], v10, s[40:43], s58 offen
  s_mov_b64 exec, 1
  buffer_store_dwordx4 v[40:43], v11, s[40:43], s58 offen
  s_branch L_od_30
L_or_29:
  s_mov_b32 exec_lo, -1
  s_mov_b32 exec_hi, 0
  buffer_store_dwordx4 v[32:35], v10, s[40:43], s58 offen sc1
  s_mov_b64 exec, 1
  buffer_store_dwordx4 v[40:43], v11, s[40:43], s58 offen sc1
L_od_30:
  s_mov_b64 exec, -1
  s_mov_b32 s52, 1
  s_branch L_h1_31_go
L_h1_31:
  s_add_u32 s52, s52, 1
  s_cmp_gt_u32 s52, 400000
  s_cbranch_scc1 L_end
L_h1_31_go:
  buffer_load_dwordx4 v[80:83], v57, s[40:43], s60 offen sc1
  buffer_load_dwordx4 v[64:67], v56, s[40:43], s60 offen sc1
  buffer_load_dwordx4 v[84:87], v57, s[40:43], s10 offen sc1
  buffer_load_dwordx4 v[68:71], v56, s[40:43], s10 offen sc1
  buffer_load_dwordx4 v[88:91], v57, s[40:43], s11 offen sc1
  buffer_load_dwordx4 v[72:75], v56, s[40:43], s11 offen sc1
  buffer_load_dwordx4 v[92:95], v57, s[40:43], s12 offen sc1
  buffer_load_dwordx4 v[76:79], v56, s[40:43], s12 offen sc1
  s_waitcnt vmcnt(0)
  v_xor_b32 v64, s94, v64
  v_xor_b32 v65, s95, v65
  v_xor_b32 v66, s96, v66
  v_xor_b32 v67, s97, v67
  v_xor_b32 v68, s94, v68
  v_xor_b32 v69, s95, v69
  v_xor_b32 v70, s96, v70
  v_xor_b32 v71, s97, v71
  v_xor_b32 v72, s94, v72
  v_xor_b32 v73, s95, v73
  v_xor_b32 v74, s96, v74
  v_xor_b32 v75, s97, v75
  v_xor_b32 v76, s94, v76
  v_xor_b32 v77, s95, v77
  v_xor_b32 v78, s96, v78
  v_xor_b32 v79, s97, v79
  v_xor_b32 v80, s94, v80
  v_xor_b32 v81, s95, v81
  v_xor_b32 v82, s96, v82
  v_xor_b32 v83, s97, v83
  v_xor_b32 v84, s94, v84
  v_xor_b32 v85, s95, v85
  v_xor_b32 v86, s96, v86
  v_xor_b32 v87, s97, v87
  v_xor_b32 v88, s94, v88
  v_xor_b32 v89, s95, v89
  v_xor_b32 v90, s96, v90
  v_xor_b32 v91, s97, v91
  v_xor_b32 v92, s94, v92
  v_xor_b32 v93, s95, v93
  v_xor_b32 v94, s96, v94
  v_xor_b32 v95, s97, v95
  v_or3_b32 v4, v64, v66, v68
  v_or3_b32 v5, v65, v67, v69
  v_or3_b32 v4, v4, v70, v72
  v_or3_b32 v5, v5, v71, v73
  v_or3_b32 v4, v4, v74, v76
  v_or3_b32 v5, v5, v75, v77
  v_or3_b32 v4, v4, v78, v80
  v_or3_b32 v5, v5, v79, v81
  v_or3_b32 v4, v4, v82, v84
  v_or3_b32 v5, v5, v83, v85
  v_or3_b32 v4, v4, v86, v88
  v_or3_b32 v5, v5, v87, v89
  v_or3_b32 v4, v4, v90, v92
  v_or3_b32 v5, v5, v91, v93
  v_or_b32 v4, v4, v94
  v_or_b32 v5, v5, v95
  v_or_b32 v4, v4, v5
  v_and_b32 v4, 0xff, v4
  v_cmp_ne_u32 vcc, 0, v4
  s_cbranch_vccnz L_h1_31
  v_max3_f32 v40, v80, v84, v88
  v_max_f32 v40, v40, v92
  v_mov_b32 v41, v40
  s_nop 1
  v_permlane32_swap_b32 v40, v41
  v_max_f32 v40, v40, v41
  v_sub_f32 v80, v80, v40
  v_sub_f32 v84, v84, v40
  v_sub_f32 v88, v88, v40
  v_sub_f32 v92, v92, v40
  v_exp_f32 v80, v80
  v_exp_f32 v84, v84
  v_exp_f32 v88, v88
  v_exp_f32 v92, v92
  v_mul_f32 v36, v80, v81
  v_pk_mul_f32 v[32:33], v[64:65], v[80:81] op_sel_hi:[1,0]
  v_pk_mul_f32 v[34:35], v[66:67], v[80:81] op_sel_hi:[1,0]
  v_fmac_f32 v36, v84, v85
  v_pk_fma_f32 v[32:33], v[68:69], v[84:85], v[32:33] op_sel_hi:[1,0,1]
  v_pk_fma_f32 v[34:35], v[70:71], v[84:85], v[34:35] op_sel_hi:[1,0,1]
  v_fmac_f32 v36, v88, v89
  v_pk_fma_f32 v[32:33], v[72:73], v[88:89], v[32:33] op_sel_hi:[1,0,1]
  v_pk_fma_f32 v[34:35], v[74:75], v[88:89], v[34:35] op_sel_hi:[1,0,1]
  v_fmac_f32 v36, v92, v93
  v_pk_fma_f32 v[32:33], v[76:77], v[92:93], v[32:33] op_sel_hi:[1,0,1]
  v_pk_fma_f32 v[34:35], v[78:79], v[92:93], v[34:35] op_sel_hi:[1,0,1]
  v_mov_b32 v41, v36
  v_permlane32_swap_b32 v32, v33
  s_nop 0
  v_permlane32_swap_b32 v36, v41
  v_permlane32_swap_b32 v34, v35
  v_add_f32 v36, v36, v41
  v_add_f32 v32, v32, v33
  v_rcp_f32 v36, v36
  v_add_f32 v34, v34, v35
  v_mul_f32 v32, v32, v36
  v_mul_f32 v34, v34, v36
  s_nop 0
  v_mov_b32_dpp v33, v32 row_shl:1 row_mask:0xf bank_mask:0xf
  v_mov_b32_dpp v35, v34 row_shl:1 row_mask:0xf bank_mask:0xf
  v_cvt_pk_bf16_f32 v64, v32, v33
  v_cvt_pk_bf16_f32 v68, v34, v35
  s_nop 0
  v_mov_b32_dpp v65, v64 row_shl:2 row_mask:0xf bank_mask:0xf
  v_mov_b32_dpp v69, v68 row_shl:2 row_mask:0xf bank_mask:0xf
  v_mov_b32_dpp v66, v64 row_shl:4 row_mask:0xf bank_mask:0xf
  v_mov_b32_dpp v70, v68 row_shl:4 row_mask:0xf bank_mask:0xf
  v_mov_b32_dpp v67, v64 row_shl:6 row_mask:0xf bank_mask:0xf
  v_mov_b32_dpp v71, v68 row_shl:6 row_mask:0xf bank_mask:0xf
  s_nop 0
  v_mfma_f32_16x16x32_bf16 v[24:27], v[64:67], v[128:131], 0
  v_mfma_f32_16x16x32_bf16 v[28:31], v[64:67], v[132:135], 0
  v_mfma_f32_16x16x32_bf16 v[32:35], v[64:67], v[136:139], 0
  v_mfma_f32_16x16x32_bf16 v[36:39], v[64:67], v[140:143], 0
  v_mfma_f32_16x16x32_bf16 v[40:43], v[64:67], v[144:147], 0
  v_mfma_f32_16x16x32_bf16 v[44:47], v[64:67], v[148:151], 0
  v_mfma_f32_16x16x32_bf16 v[48:51], v[64:67], v[152:155], 0
  v_mfma_f32_16x16x32_bf16 v[52:55], v[64:67], v[156:159], 0
  v_mfma_f32_16x16x32_bf16 v[24:27], v[68:71], v[160:163], v[24:27]
  v_mfma_f32_16x16x32_bf16 v[28:31], v[68:71], v[164:167], v[28:31]
  v_mfma_f32_16x16x32_bf16 v[32:35], v[68:71], v[168:171], v[32:35]
  v_mfma_f32_16x16x32_bf16 v[36:39], v[68:71], v[172:175], v[36:39]
  v_mfma_f32_16x16x32_bf16 v[40:43], v[68:71], v[176:179], v[40:43]
  v_mfma_f32_16x16x32_bf16 v[44:47], v[68:71], v[180:183], v[44:47]
  v_mfma_f32_16x16x32_bf16 v[48:51], v[68:71], v[184:187], v[48:51]
  v_mfma_f32_16x16x32_bf16 v[52:55], v[68:71], v[188:191], v[52:55]
  s_mov_b32 exec_lo, 0x000000ff
  s_mov_b32 exec_hi, 0x0000ff00
  ds_write2_b32 v60, v24, v28 offset0:0 offset1:1
  s_nop 0
  ds_write2_b32 v60, v32, v36 offset0:2 offset1:3
  s_nop 0
  ds_write2_b32 v60, v40, v44 offset0:4 offset1:5
  s_nop 0
  ds_write2_b32 v60, v48, v52 offset0:6 offset1:7
  s_mov_b64 exec, -1
  s_waitcnt lgkmcnt(0)
  s_barrier
  s_cmp_lg_u32 s36, 0
  s_cbranch_scc1 L_nowp_32
  s_mov_b64 exec, 0xffff
  ds_read_b128 v[24:27], v59 offset:0
  ds_read_b128 v[28:31], v59 offset:256
  ds_read_b128 v[32:35], v59 offset:512
  ds_read_b128 v[36:39], v59 offset:768
  ds_read_b128 v[40:43], v59 offset:1024
  ds_read_b128 v[44:47], v59 offset:1280
  ds_read_b128 v[48:51], v59 offset:1536
  ds_read_b128 v[52:55], v59 offset:1792
  s_waitcnt lgkmcnt(6)
  v_pk_add_f32 v[24:25], v[24:25], v[28:29]
  v_pk_add_f32 v[26:27], v[26:27], v[30:31]
  s_waitcnt lgkmcnt(4)
  v_pk_add_f32 v[32:33], v[32:33], v[36:37]
  v_pk_add_f32 v[34:35], v[34:35], v[38:39]
  v_pk_add_f32 v[24:25], v[24:25], v[32:33]
  v_pk_add_f32 v[26:27], v[26:27], v[34:35]
  s_waitcnt lgkmcnt(2)
  v_pk_add_f32 v[40:41], v[40:41], v[44:45]
  v_pk_add_f32 v[42:43], v[42:43], v[46:47]
  s_waitcnt lgkmcnt(0)
  v_pk_add_f32 v[48:49], v[48:49], v[52:53]
  v_pk_add_f32 v[50:51], v[50:51], v[54:55]
  v_pk_add_f32 v[40:41], v[40:41], v[48:49]
  v_pk_add_f32 v[42:43], v[42:43], v[50:51]
  v_pk_add_f32 v[24:25], v[24:25], v[40:41]
  v_pk_add_f32 v[26:27], v[26:27], v[42:43]
  v_perm_b32 v24, v24, v63, s98
  v_perm_b32 v25, v25, v63, s99
  v_perm_b32 v26, v26, v63, s100
  v_perm_b32 v27, v27, v63, s101
  buffer_store_dwordx4 v[24:27], v58, s[40:43], s13 offen sc1
  s_mov_b64 exec, -1
  s_cmp_eq_u32 s35, 7
  s_cbranch_scc1 L_final
  s_branch L_gtail
L_nowp_32:
  s_cmp_eq_u32 s35, 7
  s_cbranch_scc1 L_final
L_gtail:
  s_lshl_b32 s55, s36, 9
  s_add_u32 s10, s14, s55
  s_add_u32 s11, s10, 4096
  s_add_u32 s12, s10, 8192
  s_add_u32 s13, s10, 12288
  v_lshlrev_b32 v4, 3, v0
  v_perm_b32 v64, v196, v192, s38
  v_perm_b32 v65, v204, v200, s38
  v_perm_b32 v66, v212, v208, s38
  v_perm_b32 v67, v220, v216, s38
  v_perm_b32 v68, v196, v192, s39
  v_perm_b32 v69, v204, v200, s39
  v_perm_b32 v70, v212, v208, s39
  v_perm_b32 v71, v220, v216, s39
  v_perm_b32 v72, v197, v193, s38
  v_perm_b32 v73, v205, v201, s38
  v_perm_b32 v74, v213, v209, s38
  v_perm_b32 v75, v221, v217, s38
  v_perm_b32 v76, v197, v193, s39
  v_perm_b32 v77, v205, v201, s39
  v_perm_b32 v78, v213, v209, s39
  v_perm_b32 v79, v221, v217, s39
  v_perm_b32 v80, v198, v194, s38
  v_perm_b32 v81, v206, v202, s38
  v_perm_b32 v82, v214, v210, s38
  v_perm_b32 v83, v222, v218, s38
  v_perm_b32 v84, v198, v194, s39
  v_perm_b32 v85, v206, v202, s39
  v_perm_b32 v86, v214, v210, s39
  v_perm_b32 v87, v222, v218, s39
  v_perm_b32 v88, v199, v195, s38
  v_perm_b32 v89, v207, v203, s38
  v_perm_b32 v90, v215, v211, s38
  v_perm_b32 v91, v223, v219, s38
  v_perm_b32 v92, v199, v195, s39
  v_perm_b32 v93, v207, v203, s39
  v_perm_b32 v94, v215, v211, s39
  v_perm_b32 v95, v223, v219, s39
  v_perm_b32 v128, v228, v224, s38
  v_perm_b32 v129, v236, v232, s38
  v_perm_b32 v130, v244, v240, s38
  v_perm_b32 v131, v252, v248, s38
  v_perm_b32 v132, v228, v224, s39
  v_perm_b32 v133, v236, v232, s39
  v_perm_b32 v134, v244, v240, s39
  v_perm_b32 v135, v252, v248, s39
  v_perm_b32 v136, v229, v225, s38
  v_perm_b32 v137, v237, v233, s38
  v_perm_b32 v138, v245, v241, s38
  v_perm_b32 v139, v253, v249, s38
  v_perm_b32 v140, v229, v225, s39
  v_perm_b32 v141, v237, v233, s39
  v_perm_b32 v142, v245, v241, s39
  v_perm_b32 v143, v253, v249, s39
  v_perm_b32 v144, v230, v226, s38
  v_perm_b32 v145, v238, v234, s38
  v_perm_b32 v146, v246, v242, s38
  v_perm_b32 v147, v254, v250, s38
  v_perm_b32 v148, v230, v226, s39
  v_perm_b32 v149, v238, v234, s39
  v_perm_b32 v150, v246, v242, s39
  v_perm_b32 v151, v254, v250, s39
  v_perm_b32 v152, v231, v227, s38
  v_perm_b32 v153, v239, v235, s38
  v_perm_b32 v154, v247, v243, s38
  v_perm_b32 v155, v255, v251, s38
  v_perm_b32 v156, v231, v227, s39
  v_perm_b32 v157, v239, v235, s39
  v_perm_b32 v158, v247, v243, s39
  v_perm_b32 v159, v255, v251, s39
  v_and_b32 v5, 1, v0
  v_cmp_eq_u32 vcc, 1, v5
  v_mov_b32 v6, s94
  v_mov_b32 v7, s96
  v_mov_b32 v8, s95
  v_mov_b32 v9, s97
  v_cndmask_b32 v6, v6, v7, vcc
  v_cndmask_b32 v7, v8, v9, vcc
  s_lshl_b32 s55, s36, 3
  s_add_u32 s55, s55, 156800
  v_mov_b32 v56, s55
  v_mov_b32 v57, 156800
  s_lshl_b32 s55, s36, 8
  s_add_u32 s55, s55, 156864
  v_lshl_add_u32 v58, v0, 2, s55
  s_and_b32 s55, s36, 1
  s_lshl_b32 s55, s55, 9
  s_add_u32 s55, s55, 156864
  v_lshrrev_b32 v59, 2, v2
  v_lshlrev_b32 v59, 4, v59
  v_lshl_add_u32 v59, v1, 6, v59
  v_add_u32 v59, s55, v59
  s_lshl_b32 s55, s36, 9
  s_add_u32 s55, s55, 152704
  v_and_b32 v60, 3, v0
  v_lshlrev_b32 v60, 5, v60
  v_lshl_add_u32 v60, v1, 7, v60
  v_add_u32 v60, s55, v60
  v_and_b32 v10, 7, v0
  v_lshl_add_u32 v10, v1, 3, v10
  v_lshlrev_b32 v10, 2, v10
  v_lshrrev_b32 v11, 3, v2
  v_mul_u32_u24 v11, 1024, v11
  v_add_u32 v10, v11, v10
  v_add_u32 v10, 152704, v10
  v_add_u32 v3, 1024, v10
  s_mul_i32 s15, s34, 56
  s_add_u32 s15, s15, s59
  s_lshl_b32 s15, s15, 11
  s_lshl_b32 s55, s36, 9
  s_add_u32 s15, s15, s55
  s_add_u32 s15, s15, 1048576
  v_lshlrev_b32 v11, 4, v0
  s_mov_b32 s16, 0x3d372713
  s_mov_b32 s17, 0x3b000000
  s_mov_b32 s18, 0x00ff00ff
  s_mov_b32 s19, 0x00ff00ff
  s_mov_b32 s52, 1
  s_branch L_h2_33_go
L_h2_33:
  s_add_u32 s52, s52, 1
  s_cmp_gt_u32 s52, 400000
  s_cbranch_scc1 L_end
L_h2_33_go:
  buffer_load_dwordx2 v[32:33], v4, s[40:43], s10 offen offset:0 sc1
  buffer_load_dwordx2 v[34:35], v4, s[40:43], s10 offen offset:2048 sc1
  buffer_load_dwordx2 v[36:37], v4, s[40:43], s11 offen offset:0 sc1
  buffer_load_dwordx2 v[38:39], v4, s[40:43], s11 offen offset:2048 sc1
  buffer_load_dwordx2 v[40:41], v4, s[40:43], s12 offen offset:0 sc1
  buffer_load_dwordx2 v[42:43], v4, s[40:43], s12 offen offset:2048 sc1
  buffer_load_dwordx2 v[44:45], v4, s[40:43], s13 offen offset:0 sc1
  buffer_load_dwordx2 v[46:47], v4, s[40:43], s13 offen offset:2048 sc1
  s_waitcnt vmcnt(0)
  v_xor_b32 v32, v6, v32
  v_xor_b32 v33, v7, v33
  v_xor_b32 v34, v6, v34
  v_xor_b32 v35, v7, v35
  v_xor_b32 v36, v6, v36
  v_xor_b32 v37, v7, v37
  v_xor_b32 v38, v6, v38
  v_xor_b32 v39, v7, v39
  v_xor_b32 v40, v6, v40
  v_xor_b32 v41, v7, v41
  v_xor_b32 v42, v6, v42
  v_xor_b32 v43, v7, v43
  v_xor_b32 v44, v6, v44
  v_xor_b32 v45, v7, v45
  v_xor_b32 v46, v6, v46
  v_xor_b32 v47, v7, v47
  v_or3_b32 v8, v32, v34, v36
  v_or3_b32 v9, v33, v35, v37
  v_or3_b32 v8, v8, v38, v40
  v_or3_b32 v9, v9, v39, v41
  v_or3_b32 v8, v8, v42, v44
  v_or3_b32 v9, v9, v43, v45
  v_or_b32 v8, v8, v46
  v_or_b32 v9, v9, v47
  v_or_b32 v8, v8, v9
  v_and_b32 v8, 0xff, v8
  v_cmp_ne_u32 vcc, 0, v8
  s_cbranch_vccnz L_h2_33
  v_pk_add_f32 v[32:33], v[32:33], v[34:35]
  v_pk_add_f32 v[36:37], v[36:37], v[38:39]
  v_pk_add_f32 v[40:41], v[40:41], v[42:43]
  v_pk_add_f32 v[44:45], v[44:45], v[46:47]
  v_pk_add_f32 v[32:33], v[32:33], v[36:37]
  v_pk_add_f32 v[40:41], v[40:41], v[44:45]
  v_pk_add_f32 v[32:33], v[32:33], v[40:41]
  v_cvt_pk_bf16_f32 v5, v32, v33
  v_lshlrev_b32 v32, 16, v5
  v_and_b32 v33, 0xffff0000, v5
  v_pk_mul_f32 v[32:33], v[32:33], v[18:19]
  v_cvt_pk_bf16_f32 v5, v32, v33
  v_lshlrev_b32 v32, 16, v5
  v_and_b32 v33, 0xffff0000, v5
  v_pk_add_f32 v[32:33], v[32:33], v[16:17]
  v_cvt_pk_bf16_f32 v5, v32, v33
  v_lshlrev_b32 v32, 16, v5
  v_and_b32 v33, 0xffff0000, v5
  v_sub_f32 v36, v32, v15
  v_sub_f32 v37, v33, v15
  v_add_f32 v34, v36, v37
  v_mul_f32 v35, v36, v36
  v_fmac_f32 v35, v37, v37
  v_add_f32_dpp v34, v34, v34 row_ror:1 row_mask:0xf bank_mask:0xf
  s_nop 0
  v_add_f32_dpp v35, v35, v35 row_ror:1 row_mask:0xf bank_mask:0xf
  v_add_f32_dpp v34, v34, v34 row_ror:2 row_mask:0xf bank_mask:0xf
  s_nop 0
  v_add_f32_dpp v35, v35, v35 row_ror:2 row_mask:0xf bank_mask:0xf
  v_add_f32_dpp v34, v34, v34 row_ror:4 row_mask:0xf bank_mask:0xf
  s_nop 0
  v_add_f32_dpp v35, v35, v35 row_ror:4 row_mask:0xf bank_mask:0xf
  v_add_f32_dpp v34, v34, v34 row_ror:8 row_mask:0xf bank_mask:0xf
  s_nop 0
  v_add_f32_dpp v35, v35, v35 row_ror:8 row_mask:0xf bank_mask:0xf
  v_mov_b32 v36, v34
  v_mov_b32 v37, v35
  s_nop 0
  v_permlane16_swap_b32 v34, v36
  v_permlane16_swap_b32 v35, v37
  v_add_f32 v34, v34, v36
  v_add_f32 v35, v35, v37
  v_mov_b32 v36, v34
  v_mov_b32 v37, v35
  s_nop 0
  v_permlane32_swap_b32 v34, v36
  v_permlane32_swap_b32 v35, v37
  v_add_f32 v34, v34, v36
  v_add_f32 v35, v35, v37
  s_mov_b64 exec, 1
  ds_write_b64 v56, v[34:35]
  s_mov_b64 exec, -1
  s_waitcnt lgkmcnt(0)
  s_barrier
  ds_read_b128 v[36:39], v57
  ds_read_b128 v[40:43], v57 offset:16
  s_add_u32 s56, s57, 0
  buffer_load_dwordx4 v[96:99], v62, s[48:51], s56 offen offset:0
  buffer_load_dwordx4 v[100:103], v62, s[48:51], s56 offen offset:1024
  buffer_load_dwordx4 v[104:107], v62, s[48:51], s56 offen offset:2048
  buffer_load_dwordx4 v[108:111], v62, s[48:51], s56 offen offset:3072
  s_add_u32 s56, s57, 4096
  buffer_load_dwordx4 v[112:115], v62, s[48:51], s56 offen offset:0
  buffer_load_dwordx4 v[116:119], v62, s[48:51], s56 offen offset:1024
  buffer_load_dwordx4 v[120:123], v62, s[48:51], s56 offen offset:2048
  buffer_load_dwordx4 v[124:127], v62, s[48:51], s56 offen offset:3072
  s_waitcnt lgkmcnt(0)
  v_pk_add_f32 v[36:37], v[36:37], v[38:39]
  v_pk_add_f32 v[40:41], v[40:41], v[42:43]
  v_pk_add_f32 v[36:37], v[36:37], v[40:41]
  v_pk_mul_f32 v[36:37], v[36:37], s[16:17] op_sel:[0,1] op_sel_hi:[1,1]
  v_add_f32 v34, v36, v15
  v_fma_f32 v35, -v36, v36, v37
  v_max_f32 v35, 0, v35
  v_cvt_pk_bf16_f32 v44, v34, v35
  v_lshlrev_b32 v34, 16, v44
  v_and_b32 v35, 0xffff0000, v44
  v_add_f32 v35, 0x3727c5ac, v35
  v_pk_add_f32 v[38:39], v[32:33], v[34:35] op_sel_hi:[1,0] neg_lo:[0,1] neg_hi:[0,1]
  v_cvt_pk_bf16_f32 v35, v35, v35
  v_and_b32 v35, 0xffff0000, v35
  v_sqrt_f32 v35, v35
  v_cvt_pk_bf16_f32 v44, v38, v39
  v_lshlrev_b32 v38, 16, v44
  v_and_b32 v39, 0xffff0000, v44
  v_cvt_pk_bf16_f32 v35, v35, v35
  v_and_b32 v35, 0xffff0000, v35
  v_rcp_f32 v36, v35
  s_nop 0
  v_pk_mul_f32 v[32:33], v[38:39], v[36:37] op_sel_hi:[1,0]
  v_fma_f32 v38, -v32, v35, v38
  v_fma_f32 v39, -v33, v35, v39
  v_pk_fma_f32 v[32:33], v[38:39], v[36:37], v[32:33] op_sel_hi:[1,0,1]
  v_cvt_pk_bf16_f32 v44, v32, v33
  v_lshlrev_b32 v32, 16, v44
  v_and_b32 v33, 0xffff0000, v44
  v_pk_mul_f32 v[32:33], v[32:33], v[22:23]
  v_cvt_pk_bf16_f32 v44, v32, v33
  v_lshlrev_b32 v32, 16, v44
  v_and_b32 v33, 0xffff0000, v44
  v_pk_add_f32 v[32:33], v[32:33], v[20:21]
  v_cvt_pk_bf16_f32 v32, v32, v33
  ds_write_b32 v58, v32
  s_waitcnt lgkmcnt(0)
  s_barrier
  ds_read_b128 v[4:7], v59
  ds_read_b128 v[12:15], v59 offset:256
  s_waitcnt lgkmcnt(1)
  v_mfma_f32_16x16x32_bf16 v[24:27], v[4:7], v[64:67], 0
  v_mfma_f32_16x16x32_bf16 v[28:31], v[4:7], v[68:71], 0
  v_mfma_f32_16x16x32_bf16 v[32:35], v[4:7], v[72:75], 0
  v_mfma_f32_16x16x32_bf16 v[36:39], v[4:7], v[76:79], 0
  v_mfma_f32_16x16x32_bf16 v[40:43], v[4:7], v[80:83], 0
  v_mfma_f32_16x16x32_bf16 v[44:47], v[4:7], v[84:87], 0
  v_mfma_f32_16x16x32_bf16 v[48:51], v[4:7], v[88:91], 0
  v_mfma_f32_16x16x32_bf16 v[52:55], v[4:7], v[92:95], 0
  s_waitcnt lgkmcnt(0)
  v_mfma_f32_16x16x32_bf16 v[24:27], v[12:15], v[128:131], v[24:27]
  v_mfma_f32_16x16x32_bf16 v[28:31], v[12:15], v[132:135], v[28:31]
  v_mfma_f32_16x16x32_bf16 v[32:35], v[12:15], v[136:139], v[32:35]
  v_mfma_f32_16x16x32_bf16 v[36:39], v[12:15], v[140:143], v[36:39]
  v_mfma_f32_16x16x32_bf16 v[40:43], v[12:15], v[144:147], v[40:43]
  v_mfma_f32_16x16x32_bf16 v[44:47], v[12:15], v[148:151], v[44:47]
  v_mfma_f32_16x16x32_bf16 v[48:51], v[12:15], v[152:155], v[48:51]
  v_mfma_f32_16x16x32_bf16 v[52:55], v[12:15], v[156:159], v[52:55]
  s_mov_b32 exec_lo, 0x00f0000f
  s_mov_b32 exec_hi, 0xf0000f00
  ds_write2_b32 v60, v24, v28 offset0:0 offset1:1
  s_nop 0
  ds_write2_b32 v60, v32, v36 offset0:2 offset1:3
  s_nop 0
  ds_write2_b32 v60, v40, v44 offset0:4 offset1:5
  s_nop 0
  ds_write2_b32 v60, v48, v52 offset0:6 offset1:7
  s_mov_b64 exec, -1
  s_waitcnt lgkmcnt(0)
  s_barrier
  ds_read2_b32 v[24:25], v10 offset0:0 offset1:32
  ds_read2_b32 v[26:27], v10 offset0:64 offset1:96
  ds_read2_b32 v[28:29], v10 offset0:128 offset1:160
  ds_read2_b32 v[30:31], v10 offset0:192 offset1:224
  s_waitcnt lgkmcnt(2)
  v_pk_add_f32 v[24:25], v[24:25], v[26:27]
  s_waitcnt lgkmcnt(0)
  v_pk_add_f32 v[28:29], v[28:29], v[30:31]
  v_pk_add_f32 v[24:25], v[24:25], v[28:29]
  v_add_f32 v24, v24, v25
  v_cvt_pk_bf16_f32 v24, v24, v24
  v_and_b32 v24, 0xffff0000, v24
  v_mul_f32 v26, v24, v24
  v_fma_f32 v26, v26, s16, 1.0
  v_mov_b32_dpp v25, v24 row_ror:8 row_mask:0xf bank_mask:0xf
  v_mul_f32 v26, v26, v24
  v_mul_f32 v26, 0xc0135761, v26
  v_exp_f32 v26, v26
  s_nop 0
  v_add_f32 v26, 1.0, v26
  v_rcp_f32 v26, v26
  s_nop 0
  v_mul_f32 v26, v26, v24
  v_cvt_pk_bf16_f32 v26, v26, v26
  v_and_b32 v26, 0xffff0000, v26
  v_mul_f32 v26, v26, v25
  s_waitcnt vmcnt(0)
  v_perm_b32 v160, v100, v96, s38
  v_perm_b32 v161, v108, v104, s38
  v_perm_b32 v162, v116, v112, s38
  v_perm_b32 v163, v124, v120, s38
  v_mov_b32_dpp v27, v26 row_shl:1 row_mask:0xf bank_mask:0xf
  v_cvt_pk_bf16_f32 v4, v26, v27
  s_nop 1
  v_mov_b32_dpp v5, v4 row_shl:2 row_mask:0xf bank_mask:0xf
  v_mov_b32_dpp v6, v4 row_shl:4 row_mask:0xf bank_mask:0xf
  v_mov_b32_dpp v7, v4 row_shl:6 row_mask:0xf bank_mask:0xf
  v_perm_b32 v164, v100, v96, s39
  v_perm_b32 v165, v108, v104, s39
  v_perm_b32 v166, v116, v112, s39
  v_perm_b32 v167, v124, v120, s39
  v_mfma_f32_16x16x32_bf16 v[24:27], v[4:7], v[160:163], 0
  v_perm_b32 v168, v101, v97, s38
  v_perm_b32 v169, v109, v105, s38
  v_perm_b32 v170, v117, v113, s38
  v_perm_b32 v171, v125, v121, s38
  v_mfma_f32_16x16x32_bf16 v[28:31], v[4:7], v[164:167], 0
  v_perm_b32 v172, v101, v97, s39
  v_perm_b32 v173, v109, v105, s39
  v_perm_b32 v174, v117, v113, s39
  v_perm_b32 v175, v125, v121, s39
  v_mfma_f32_16x16x32_bf16 v[32:35], v[4:7], v[168:171], 0
  v_perm_b32 v176, v102, v98, s38
  v_perm_b32 v177, v110, v106, s38
  v_perm_b32 v178, v118, v114, s38
  v_perm_b32 v179, v126, v122, s38
  v_mfma_f32_16x16x32_bf16 v[36:39], v[4:7], v[172:175], 0
  v_perm_b32 v180, v102, v98, s39
  v_perm_b32 v181, v110, v106, s39
  v_perm_b32 v182, v118, v114, s39
  v_perm_b32 v183, v126, v122, s39
  v_mfma_f32_16x16x32_bf16 v[40:43], v[4:7], v[176:179], 0
  v_perm_b32 v184, v103, v99, s38
  v_perm_b32 v185, v111, v107, s38
  v_perm_b32 v186, v119, v115, s38
  v_perm_b32 v187, v127, v123, s38
  v_mfma_f32_16x16x32_bf16 v[44:47], v[4:7], v[180:183], 0
  v_perm_b32 v188, v103, v99, s39
  v_perm_b32 v189, v111, v107, s39
  v_perm_b32 v190, v119, v115, s39
  v_perm_b32 v191, v127, v123, s39
  v_mfma_f32_16x16x32_bf16 v[48:51], v[4:7], v[184:187], 0
  s_nop 0
  v_mfma_f32_16x16x32_bf16 v[52:55], v[4:7], v[188:191], 0
  v_perm_b32 v12, v24, v63, s98
  v_perm_b32 v13, v28, v63, s99
  v_perm_b32 v14, v32, v63, s100
  v_perm_b32 v15, v36, v63, s101
  v_perm_b32 v16, v40, v63, s98
  v_perm_b32 v17, v44, v63, s99
  v_perm_b32 v18, v48, v63, s100
  s_nop 0
  v_perm_b32 v19, v52, v63, s101
  s_mov_b64 exec, 0xffff
  buffer_store_dwordx4 v[12:15], v11, s[40:43], s15 offen sc1
  buffer_store_dwordx4 v[16:19], v11, s[40:43], s15 offen offset:256 sc1
  s_branch L_fin
L_final:
  v_lshrrev_b32 v4, 2, v0
  v_lshlrev_b32 v5, 11, v4
  v_lshl_add_u32 v8, v7, 2, v5
  v_mov_b32 v9, 0x7ffffff0
  v_cmp_gt_u32 vcc, 8, v4
  v_and_b32 v6, 3, v0
  v_lshl_add_u32 v10, v6, 4, v5
  v_cndmask_b32 v8, v9, v8, vcc
  v_cndmask_b32 v11, v9, v10, vcc
  s_mul_i32 s56, s34, 114688
  s_add_u32 s56, s56, 1048576
  s_lshr_b32 s57, s32, 1
  s_lshl_b32 s57, s57, 9
  s_add_u32 s56, s56, s57
  s_and_b32 s57, s36, 1
  s_lshl_b32 s57, s57, 8
  s_add_u32 s56, s56, s57
  s_lshl_b32 s57, s62, 4
  s_add_u32 s56, s56, s57
  s_add_u32 s57, s56, 32768
  s_add_u32 s58, s56, 65536
  s_add_u32 s59, s56, 98304
  s_mov_b32 s48, s26
  s_and_b32 s49, s27, 0xffff
  s_mov_b32 s50, 0x00001000
  s_mov_b32 s51, 0x20000
  v_lshlrev_b32 v7, 1, v7
  s_lshl_b32 s60, s34, 10
  v_mov_b32 v40, s94
  v_cndmask_b32 v44, 0, v40, vcc
  v_mov_b32 v41, s95
  v_cndmask_b32 v45, 0, v41, vcc
  v_mov_b32 v42, s96
  v_cndmask_b32 v46, 0, v42, vcc
  v_mov_b32 v43, s97
  v_cndmask_b32 v47, 0, v43, vcc
  s_mov_b32 s52, 1
  s_branch L_fw_34_go
L_fw_34:
  s_add_u32 s52, s52, 1
  s_cmp_gt_u32 s52, 400000
  s_cbranch_scc1 L_end
L_fw_34_go:
  buffer_load_dwordx4 v[24:27], v8, s[40:43], s14 offen sc1
  s_waitcnt vmcnt(0)
  v_xor_b32 v24, v44, v24
  v_xor_b32 v25, v45, v25
  v_xor_b32 v26, v46, v26
  v_xor_b32 v27, v47, v27
  v_or3_b32 v5, v24, v25, v26
  v_or_b32 v5, v5, v27
  v_and_b32 v5, 0xff, v5
  v_cmp_ne_u32 vcc, 0, v5
  s_cbranch_vccnz L_fw_34
  v_add_f32_dpp v24, v24, v24 row_ror:4 row_mask:0xf bank_mask:0xf
  v_add_f32_dpp v25, v25, v25 row_ror:4 row_mask:0xf bank_mask:0xf
  v_add_f32_dpp v26, v26, v26 row_ror:4 row_mask:0xf bank_mask:0xf
  v_add_f32_dpp v27, v27, v27 row_ror:4 row_mask:0xf bank_mask:0xf
  v_add_f32_dpp v24, v24, v24 row_ror:8 row_mask:0xf bank_mask:0xf
  v_add_f32_dpp v25, v25, v25 row_ror:8 row_mask:0xf bank_mask:0xf
  v_add_f32_dpp v26, v26, v26 row_ror:8 row_mask:0xf bank_mask:0xf
  v_add_f32_dpp v27, v27, v27 row_ror:8 row_mask:0xf bank_mask:0xf
  v_permlane16_swap_b32 v24, v25
  s_nop 0
  v_permlane16_swap_b32 v26, v27
  v_add_f32 v24, v24, v25
  v_add_f32 v26, v26, v27
  s_nop 1
  v_permlane32_swap_b32 v24, v26
  v_add_f32 v24, v24, v26
  v_cvt_pk_bf16_f32 v24, v24, v24
  v_and_b32 v24, 0xffff0000, v24
  v_mul_f32 v24, v24, v20
  v_cvt_pk_bf16_f32 v24, v24, v24
  v_and_b32 v24, 0xffff0000, v24
  v_add_f32 v16, v16, v24
  v_cvt_pk_bf16_f32 v16, v16, v16
  v_and_b32 v16, 0xffff0000, v16
  v_lshl_add_u32 v7, v1, 1, v7
  s_mov_b32 s52, 1
  s_branch L_h3_35_go
L_h3_35:
  s_add_u32 s52, s52, 1
  s_cmp_gt_u32 s52, 400000
  s_cbranch_scc1 L_end
L_h3_35_go:
  buffer_load_dwordx4 v[24:27], v10, s[40:43], s56 offen sc1
  buffer_load_dwordx4 v[28:31], v10, s[40:43], s57 offen sc1
  buffer_load_dwordx4 v[32:35], v10, s[40:43], s58 offen sc1
  buffer_load_dwordx4 v[36:39], v11, s[40:43], s59 offen sc1
  s_waitcnt vmcnt(0)
  v_xor_b32 v24, v40, v24
  v_xor_b32 v25, v41, v25
  v_xor_b32 v26, v42, v26
  v_xor_b32 v27, v43, v27
  v_xor_b32 v28, v40, v28
  v_xor_b32 v29, v41, v29
  v_xor_b32 v30, v42, v30
  v_xor_b32 v31, v43, v31
  v_xor_b32 v32, v40, v32
  v_xor_b32 v33, v41, v33
  v_xor_b32 v34, v42, v34
  v_xor_b32 v35, v43, v35
  v_xor_b32 v36, v44, v36
  v_xor_b32 v37, v45, v37
  v_xor_b32 v38, v46, v38
  v_xor_b32 v39, v47, v39
  v_or3_b32 v5, v24, v26, v28
  v_or3_b32 v6, v25, v27, v29
  v_or3_b32 v5, v5, v30, v32
  v_or3_b32 v6, v6, v31, v33
  v_or3_b32 v5, v5, v34, v36
  v_or3_b32 v6, v6, v35, v37
  v_or_b32 v5, v5, v38
  v_or_b32 v6, v6, v39
  v_or_b32 v5, v5, v6
  v_and_b32 v5, 0xff, v5
  v_cmp_ne_u32 vcc, 0, v5
  s_cbranch_vccnz L_h3_35
  v_pk_add_f32 v[24:25], v[24:25], v[28:29]
  v_pk_add_f32 v[32:33], v[32:33], v[36:37]
  v_pk_add_f32 v[26:27], v[26:27], v[30:31]
  v_pk_add_f32 v[34:35], v[34:35], v[38:39]
  v_pk_add_f32 v[24:25], v[24:25], v[32:33]
  v_pk_add_f32 v[26:27], v[26:27], v[34:35]
  s_nop 0
  v_add_f32_dpp v24, v24, v24 row_ror:4 row_mask:0xf bank_mask:0xf
  v_add_f32_dpp v25, v25, v25 row_ror:4 row_mask:0xf bank_mask:0xf
  v_add_f32_dpp v26, v26, v26 row_ror:4 row_mask:0xf bank_mask:0xf
  v_add_f32_dpp v27, v27, v27 row_ror:4 row_mask:0xf bank_mask:0xf
  v_add_f32_dpp v24, v24, v24 row_ror:8 row_mask:0xf bank_mask:0xf
  v_add_f32_dpp v25, v25, v25 row_ror:8 row_mask:0xf bank_mask:0xf
  v_add_f32_dpp v26, v26, v26 row_ror:8 row_mask:0xf bank_mask:0xf
  v_add_f32_dpp v27, v27, v27 row_ror:8 row_mask:0xf bank_mask:0xf
  v_permlane16_swap_b32 v24, v25
  s_nop 0
  v_permlane16_swap_b32 v26, v27
  v_add_f32 v24, v24, v25
  v_add_f32 v26, v26, v27
  s_nop 1
  v_permlane32_swap_b32 v24, v26
  v_add_f32 v24, v24, v26
  v_cvt_pk_bf16_f32 v24, v24, v24
  v_and_b32 v24, 0xffff0000, v24
  v_mul_f32 v24, v24, v12
  v_cvt_pk_bf16_f32 v24, v24, v24
  v_and_b32 v24, 0xffff0000, v24
  v_add_f32 v24, v24, v16
  s_mov_b32 exec_lo, 0x000f000f
  s_mov_b32 exec_hi, 0x000f000f
  v_cvt_pk_bf16_f32 v24, v24, v24
  buffer_store_short v24, v7, s[48:51], s60 offen
  s_cmp_lg_u32 s2, 255
  s_cbranch_scc1 L_noep_36
  s_cmp_lg_u32 s36, 0
  s_cbranch_scc1 L_noep_36
  v_mov_b32 v4, s37
  v_mov_b32 v5, 0
  s_mov_b64 exec, 1
  buffer_store_dword v4, v5, s[40:43], 0 offen offset:0
L_noep_36:
L_fin:
L_end:
  s_endpgm
L_code_end:
.section .rodata,"a"
.p2align 6
.amdhsa_kernel adaLN_cond__gqa_block_cached__glu_gated_geglu__decode_kernel
  .amdhsa_next_free_vgpr 256
  .amdhsa_next_free_sgpr 102
  .amdhsa_accum_offset 256
  .amdhsa_group_segment_fixed_size 0
  .amdhsa_kernarg_size 112
  .amdhsa_user_sgpr_count 2
  .amdhsa_user_sgpr_kernarg_segment_ptr 1
  .amdhsa_system_sgpr_workgroup_id_x 1
  .amdhsa_float_denorm_mode_32 3
.end_amdhsa_kernel
```
